```python
import torch

def _softmax(x, axis=-1):
    return torch.softmax(x, dim=axis)
def _gelu(x):
    return torch.nn.functional.gelu(x, approximate="tanh")
def _silu(x):
    return torch.nn.functional.silu(x)
def _sigmoid(x):
    return torch.sigmoid(x)
def _layernorm(x, axis=-1, eps=1e-5):
    m = x.mean(dim=axis, keepdim=True)
    v = x.var(dim=axis, keepdim=True, unbiased=False)
    return (x - m) / torch.sqrt(v + eps)
def _scatter_add(tgt, idx, src, axis=0):
    return tgt.clone().index_add_(axis, idx, src)
def _segment_sum(src, seg, n):
    out = torch.zeros((n,) + src.shape[1:], dtype=src.dtype)
    return out.index_add_(0, seg, src)
def _pad(x, pw):
    flat = tuple(v for pair in reversed(pw) for v in pair)
    return torch.nn.functional.pad(x, flat)

kernel_name = 'standalone__mixer_token_mlp__prompt'

def setup_inputs():

    _w = (lambda a: (lambda t: t.to(torch.bfloat16) if t.is_floating_point() else t)(torch.as_tensor(a)))
    B, S, D, F = 1, 2048, 512, 1792
    return {
        "x": _w((lambda *s: torch.randn(*s, dtype=torch.bfloat16) * 0.05)(B, S, D)),
        "w1": _w((lambda *s: torch.randn(*s, dtype=torch.bfloat16) * 0.2)(S, F) * (S ** -0.5)),
        "b1": _w((lambda *s: torch.randn(*s, dtype=torch.bfloat16) * 3.2)(F) * 0.02),
        "w2": _w((lambda *s: torch.randn(*s, dtype=torch.bfloat16) * 0.05)(F, S) * (F ** -0.5)),
        "b2": _w((lambda *s: torch.randn(*s, dtype=torch.bfloat16) * 0.1)(S) * 0.02),
    }

def reference(x, w1, b1, w2, b2):
    B, S, D = x.shape
    h = _layernorm(x, axis=-1)
    u = torch.einsum("bsd,sf->bdf", h, w1) + b1
    u = _gelu(u)
    y = torch.einsum("bdf,fs->bds", u, w2) + b2
    return (lambda x, *d: x.permute(*d))(y, 0, 2, 1)
```

```asm
; @launch grid=(256,1,1) block=(256,1,1) lds=163840
.amdgcn_target "amdgcn-amd-amdhsa--gfx950"
.text
.globl standalone__mixer_token_mlp__prompt_kernel
.p2align 8
.type standalone__mixer_token_mlp__prompt_kernel,@function
standalone__mixer_token_mlp__prompt_kernel:
    s_cmp_ge_u32 s2, 256
    s_cbranch_scc1 L_done
    s_load_dwordx16 s[4:19], s[0:1], 0
    s_getpc_b64 s[48:49]
L_pc0:
    v_lshrrev_b32 v1, 6, v0
    v_and_b32 v2, 63, v0
    v_lshlrev_b32 v19, 4, v2
    v_readfirstlane_b32 s32, v1
    s_lshr_b32 s41, s2, 3
    s_lshl_b32 s44, s41, 9
    v_and_b32 v35, 1, v0
    v_lshlrev_b32 v35, 14, v35
    v_lshl_add_u32 v35, v1, 7, v35
    v_add_u32 v35, s44, v35
    v_min_u32 v35, L_end-L_pc0-4, v35
    v_cmp_gt_u32 vcc, 8, v2
    v_lshlrev_b32 v36, 10, v1
    v_lshl_add_u32 v36, v2, 7, v36
    v_cndmask_b32 v35, v35, v36, vcc
    global_load_dword v26, v35, s[48:49]
    v_lshl_add_u32 v34, v1, 11, v19
    s_lshl_b32 s40, s2, 13
    v_add_u32 v34, s40, v34
    s_and_b32 s40, s2, 7
    s_mul_i32 s42, s40, 28
    s_add_u32 s42, s42, s41
    s_and_b32 s33, s42, 7
    s_lshr_b32 s42, s42, 3
    s_lshr_b32 s44, s40, 1
    s_mul_i32 s44, s44, 7
    s_add_u32 s44, s44, 3
    s_cmp_lt_u32 s41, 28
    s_cselect_b32 s34, s42, s44
    v_lshrrev_b32 v36, 3, v2
    v_and_b32 v37, 7, v2
    v_and_b32 v38, 2, v36
    v_xor_b32 v38, v38, v37
    v_mul_u32_u24 v5, 3584, v36
    v_lshl_add_u32 v3, v38, 4, v5
    s_waitcnt lgkmcnt(0)
    global_load_dwordx4 v[120:123], v34, s[4:5]
    global_load_dwordx4 v[124:127], v34, s[4:5] offset:1024
    s_mul_i32 s42, s40, 1
    s_add_u32 s42, s42, s33
    s_and_b32 s52, s42, 7
    s_lshr_b32 s46, s41, 2
    s_lshl_b32 s42, s40, 2
    s_and_b32 s43, s41, 3
    s_add_u32 s35, s42, s43
    v_lshrrev_b32 v39, 4, v2
    s_and_b32 s42, s32, 1
    s_lshl_b32 s42, s42, 6
    s_lshl_b32 s43, s34, 7
    s_add_u32 s42, s42, s43
    v_lshl_add_u32 v52, v39, 3, s42
    s_mul_i32 s53, s32, 1835008
    s_add_u32 s53, s53, s43
    s_lshl_b32 s42, s35, 6
    s_lshl_b32 s43, s32, 4
    s_add_u32 s42, s42, s43
    v_and_b32 v53, 15, v2
    v_add_u32 v53, s42, v53
    v_lshlrev_b32 v54, 1, v53
    global_load_dwordx2 v[48:49], v52, s[8:9]
    global_load_dwordx2 v[50:51], v52, s[8:9] offset:32
    global_load_ushort v25, v54, s[12:13]
    s_mul_i32 s36, s32, 28672
    s_add_u32 s36, s36, 49152
    s_mov_b32 s20, s6
    s_mov_b32 s21, s7
    s_mov_b32 s22, 7340032
    s_mov_b32 s23, 0x20000
    v_xor_b32 v38, 4, v38
    v_lshl_add_u32 v4, v38, 4, v5
    v_add_u32 v4, 27648, v4
    v_add_u32 v5, 55296, v3
    v_add_u32 v6, 55296, v4
    s_add_u32 m0, s36, 0
    s_mul_i32 s40, s52, 229376
    s_add_u32 s37, s53, s40
    buffer_load_dwordx4 v3, s[20:23], s37 offen offset:0 lds
    buffer_load_dwordx4 v4, s[20:23], s37 offen offset:1024 lds
    buffer_load_dwordx4 v5, s[20:23], s37 offen offset:2048 lds
    buffer_load_dwordx4 v6, s[20:23], s37 offen offset:3072 lds
    s_add_u32 m0, s36, 4096
    s_add_u32 s37, s37, 114688
    buffer_load_dwordx4 v3, s[20:23], s37 offen offset:0 lds
    buffer_load_dwordx4 v4, s[20:23], s37 offen offset:1024 lds
    buffer_load_dwordx4 v5, s[20:23], s37 offen offset:2048 lds
    buffer_load_dwordx4 v6, s[20:23], s37 offen offset:3072 lds
    s_add_u32 s50, s18, 4718592
    s_addc_u32 s51, s19, 0
    s_load_dword s39, s[50:51], 0
    s_mov_b32 s24, s10
    s_mov_b32 s25, s11
    s_mov_b32 s26, 7340032
    s_mov_b32 s27, 0x20000
    s_mov_b32 s28, s18
    s_mov_b32 s29, s19
    s_mov_b32 s30, 0x1000000
    s_mov_b32 s31, 0x20000
    s_mov_b32 s47, 0xffff0000
    s_mov_b32 s67, 1
    v_lshlrev_b32 v168, 5, v2
    v_lshl_add_u32 v168, v1, 11, v168
    v_add_u32 v168, 24576, v168
    v_and_b32 v34, 0xe3, v0
    v_bfe_u32 v35, v2, 2, 2
    v_lshl_add_u32 v34, v35, 3, v34
    v_bfe_u32 v35, v2, 4, 1
    v_lshl_add_u32 v34, v35, 2, v34
    v_lshlrev_b32 v169, 2, v34
    v_add_u32 v169, 24576, v169
    v_and_b32 v170, 15, v0
    v_lshlrev_b32 v170, 4, v170
    v_lshl_add_u32 v170, v35, 10, v170
    v_lshrrev_b32 v35, 5, v0
    v_lshl_add_u32 v170, v35, 17, v170
    s_lshr_b32 s40, s2, 2
    s_lshl_b32 s40, s40, 11
    s_and_b32 s41, s2, 3
    s_lshl_b32 s41, s41, 8
    s_add_u32 s40, s40, s41
    v_add_u32 v170, s40, v170
    v_bfe_u32 v35, v170, 7, 3
    v_cmp_eq_u32 vcc, 3, v35
    v_add_u32 v35, 6291328, v170
    s_nop 0
    v_cndmask_b32 v170, v170, v35, vcc
    v_add_u32 v171, 1048576, v170
    s_lshl_b32 s40, s2, 4
    s_lshl_b32 s41, s32, 12
    s_add_u32 s40, s40, s41
    s_add_u32 s66, s40, 4194304
    v_mov_b32 v184, s66
    s_lshr_b32 s40, s2, 3
    s_and_b32 s40, s40, 3
    s_xor_b32 s40, s40, s32
    s_lshr_b32 s41, s2, 6
    s_or_b32 s71, s40, s41
    s_lshl_b32 s40, s2, 7
    s_add_u32 s40, s40, 4456448
    v_mov_b32 v185, s40
    v_and_b32 v34, 6, v36
    v_xor_b32 v34, v34, v37
    v_lshlrev_b32 v34, 4, v34
    v_lshl_add_u32 v7, v36, 12, v34
    v_add_u32 v8, 31744, v7
    v_add_u32 v9, 63488, v7
    v_add_u32 v10, 95232, v7
    s_mul_i32 s68, s32, 1835008
    s_lshl_b32 s42, s35, 7
    s_add_u32 s68, s68, s42
    s_sub_u32 s68, s68, 131072
    v_lshlrev_b32 v24, 10, v53
    v_lshl_add_u32 v24, v39, 4, v24
    s_lshl_b32 s40, s46, 7
    v_add_u32 v24, s40, v24
    v_bfe_u32 v35, v2, 2, 2
    v_lshlrev_b32 v34, 7, v35
    v_and_b32 v36, 3, v2
    v_lshl_add_u32 v34, v36, 3, v34
    v_add_u32 v34, s36, v34
    v_lshrrev_b32 v35, 1, v35
    v_and_b32 v36, 1, v39
    v_lshl_add_u32 v35, v36, 1, v35
    v_and_b32 v36, 1, v1
    v_lshlrev_b32 v36, 1, v36
    v_xor_b32 v36, v36, v35
    v_lshl_add_u32 v11, v39, 10, v34
    v_lshl_add_u32 v11, v36, 5, v11
    v_xor_b32 v12, 32, v11
    v_xor_b32 v13, 64, v11
    v_xor_b32 v14, 96, v11
    v_xor_b32 v36, v1, v35
    v_lshl_add_u32 v15, v39, 9, v34
    v_lshl_add_u32 v15, v36, 5, v15
    v_xor_b32 v16, 32, v15
    v_xor_b32 v17, 64, v15
    v_xor_b32 v18, 96, v15
    v_lshrrev_b32 v37, 3, v2
    v_cmp_eq_u32 vcc, 3, v37
    v_add_u32 v37, 6291328, v19
    s_nop 0
    v_cndmask_b32 v31, v19, v37, vcc
    v_lshrrev_b32 v37, 1, v1
    v_lshl_add_u32 v20, v37, 10, v31
    v_xor_b32 v21, 0x400, v20
    s_and_b32 s40, s33, 3
    s_lshl_b32 s40, s40, 12
    s_add_u32 s40, s40, 4194304
    v_lshlrev_b32 v22, 4, v0
    v_add_u32 v22, s40, v22
    s_lshl_b32 s54, s33, 18
    s_lshl_b32 s40, s32, 15
    s_add_u32 s54, s54, s40
    s_mul_i32 s57, s46, 229376
    s_mul_i32 s40, s32, 28672
    s_add_u32 s57, s57, s40
    s_add_u32 s57, s57, 2097152
    s_lshl_b32 s40, s46, 3
    s_add_u32 s40, s40, s32
    s_lshl_b32 s40, s40, 7
    s_add_u32 s65, s40, 4456448
    s_mul_i32 s40, s34, 37
    s_lshr_b32 s40, s40, 8
    s_lshl_b32 s42, s33, 3
    s_add_u32 s40, s40, s42
    s_lshl_b32 s40, s40, 7
    s_add_u32 s64, s40, 4456448
    s_mul_i32 s79, s32, 6144
    v_add_u32 v27, s79, v19
    v_lshlrev_b32 v34, 2, v2
    s_xor_b32 s41, s32, 1
    s_mul_i32 s41, s41, 6144
    v_add_u32 v28, s41, v19
    v_add_u32 v186, s41, v34
    s_xor_b32 s41, s32, 2
    s_mul_i32 s41, s41, 6144
    v_add_u32 v29, s41, v19
    v_add_u32 v187, s41, v34
    s_xor_b32 s41, s32, 3
    s_mul_i32 s41, s41, 6144
    v_add_u32 v30, s41, v19
    v_add_u32 v188, s41, v34
    s_mul_i32 s56, s33, 229376
    s_lshl_b32 s40, s34, 12
    s_add_u32 s56, s56, s40
    s_and_b32 s40, s32, 1
    s_lshl_b32 s40, s40, 11
    s_add_u32 s56, s56, s40
    s_lshr_b32 s40, s32, 1
    s_lshl_b32 s40, s40, 10
    s_add_u32 s56, s56, s40
    s_add_u32 s56, s56, 2097152
    v_mov_b32 v176, 0xbdd2d3e8
    v_mov_b32 v177, 0xbdd2d3e8
    v_mov_b32 v178, 0xc0135761
    v_mov_b32 v179, 0xc0135761
    v_mov_b32 v180, 1.0
    v_mov_b32 v181, 1.0
    s_waitcnt vmcnt(11)
    v_lshlrev_b32 v128, 16, v120
    v_and_b32 v129, s47, v120
    v_lshlrev_b32 v130, 16, v121
    v_and_b32 v131, s47, v121
    v_lshlrev_b32 v132, 16, v122
    v_and_b32 v133, s47, v122
    v_lshlrev_b32 v134, 16, v123
    v_and_b32 v135, s47, v123
    v_lshlrev_b32 v136, 16, v124
    v_and_b32 v137, s47, v124
    v_lshlrev_b32 v138, 16, v125
    v_and_b32 v139, s47, v125
    v_lshlrev_b32 v140, 16, v126
    v_and_b32 v141, s47, v126
    v_lshlrev_b32 v142, 16, v127
    v_and_b32 v143, s47, v127
    v_pk_add_f32 v[144:145], v[128:129], v[130:131]
    v_pk_add_f32 v[146:147], v[132:133], v[134:135]
    v_pk_add_f32 v[148:149], v[136:137], v[138:139]
    v_pk_add_f32 v[150:151], v[140:141], v[142:143]
    v_pk_add_f32 v[144:145], v[144:145], v[146:147]
    v_pk_add_f32 v[148:149], v[148:149], v[150:151]
    v_add_f32 v144, v144, v145
    v_add_f32 v148, v148, v149
    s_nop 1
    v_permlane32_swap_b32 v144, v148
    v_add_f32 v144, v144, v148
    v_mov_b32 v145, v144
    s_nop 1
    v_permlane16_swap_b32 v144, v145
    v_add_f32 v144, v144, v145
    s_nop 1
    v_add_f32_dpp v144, v144, v144 quad_perm:[1,0,3,2] row_mask:0xf bank_mask:0xf
    s_nop 1
    v_add_f32_dpp v144, v144, v144 quad_perm:[2,3,0,1] row_mask:0xf bank_mask:0xf
    s_nop 1
    v_add_f32_dpp v144, v144, v144 row_half_mirror row_mask:0xf bank_mask:0xf
    s_nop 1
    v_add_f32_dpp v144, v144, v144 row_mirror row_mask:0xf bank_mask:0xf
    v_mul_f32 v144, 0x3b000000, v144
    s_nop 0
    v_readlane_b32 s40, v144, 0
    v_readlane_b32 s41, v144, 32
    v_cvt_pk_bf16_f32 v151, 0, v144
    s_nop 1
    v_subrev_f32 v152, s40, v128
    v_subrev_f32 v153, s40, v129
    v_subrev_f32 v154, s40, v130
    v_subrev_f32 v155, s40, v131
    v_subrev_f32 v156, s40, v132
    v_subrev_f32 v157, s40, v133
    v_subrev_f32 v158, s40, v134
    v_subrev_f32 v159, s40, v135
    v_subrev_f32 v160, s41, v136
    v_subrev_f32 v161, s41, v137
    v_subrev_f32 v162, s41, v138
    v_subrev_f32 v163, s41, v139
    v_subrev_f32 v164, s41, v140
    v_subrev_f32 v165, s41, v141
    v_subrev_f32 v166, s41, v142
    v_subrev_f32 v167, s41, v143
    v_readlane_b32 s42, v151, 0
    v_readlane_b32 s43, v151, 32
    v_pk_mul_f32 v[144:145], v[152:153], v[152:153]
    v_pk_mul_f32 v[148:149], v[160:161], v[160:161]
    v_pk_fma_f32 v[144:145], v[154:155], v[154:155], v[144:145]
    v_pk_fma_f32 v[148:149], v[162:163], v[162:163], v[148:149]
    v_pk_fma_f32 v[144:145], v[156:157], v[156:157], v[144:145]
    v_pk_fma_f32 v[148:149], v[164:165], v[164:165], v[148:149]
    v_pk_fma_f32 v[144:145], v[158:159], v[158:159], v[144:145]
    v_pk_fma_f32 v[148:149], v[166:167], v[166:167], v[148:149]
    v_add_f32 v144, v144, v145
    v_add_f32 v148, v148, v149
    v_subrev_f32 v152, s42, v128
    v_subrev_f32 v160, s43, v136
    v_permlane32_swap_b32 v144, v148
    v_add_f32 v144, v144, v148
    v_mov_b32 v145, v144
    v_subrev_f32 v153, s42, v129
    v_subrev_f32 v161, s43, v137
    v_permlane16_swap_b32 v144, v145
    v_add_f32 v144, v144, v145
    v_subrev_f32 v154, s42, v130
    v_subrev_f32 v162, s43, v138
    v_add_f32_dpp v144, v144, v144 quad_perm:[1,0,3,2] row_mask:0xf bank_mask:0xf
    v_subrev_f32 v155, s42, v131
    v_subrev_f32 v163, s43, v139
    v_add_f32_dpp v144, v144, v144 quad_perm:[2,3,0,1] row_mask:0xf bank_mask:0xf
    v_subrev_f32 v156, s42, v132
    v_subrev_f32 v164, s43, v140
    v_add_f32_dpp v144, v144, v144 row_half_mirror row_mask:0xf bank_mask:0xf
    v_subrev_f32 v157, s42, v133
    v_subrev_f32 v165, s43, v141
    v_add_f32_dpp v144, v144, v144 row_mirror row_mask:0xf bank_mask:0xf
    v_mul_f32 v144, 0x3b000000, v144
    v_cvt_pk_bf16_f32 v144, 0, v144
    v_add_f32 v144, 0x3727c5ac, v144
    v_cvt_pk_bf16_f32 v144, 0, v144
    v_sqrt_f32 v144, v144
    v_subrev_f32 v158, s42, v134
    v_subrev_f32 v166, s43, v142
    v_cvt_pk_bf16_f32 v144, 0, v144
    v_rcp_f32 v144, v144
    v_subrev_f32 v159, s42, v135
    v_subrev_f32 v167, s43, v143
    v_readlane_b32 s44, v144, 0
    v_readlane_b32 s45, v144, 32
    v_cvt_pk_bf16_f32 v152, 0, v152
    v_cvt_pk_bf16_f32 v153, 0, v153
    v_cvt_pk_bf16_f32 v154, 0, v154
    v_cvt_pk_bf16_f32 v155, 0, v155
    v_cvt_pk_bf16_f32 v156, 0, v156
    v_cvt_pk_bf16_f32 v157, 0, v157
    v_cvt_pk_bf16_f32 v158, 0, v158
    v_cvt_pk_bf16_f32 v159, 0, v159
    v_cvt_pk_bf16_f32 v160, 0, v160
    v_cvt_pk_bf16_f32 v161, 0, v161
    v_cvt_pk_bf16_f32 v162, 0, v162
    v_cvt_pk_bf16_f32 v163, 0, v163
    v_cvt_pk_bf16_f32 v164, 0, v164
    v_cvt_pk_bf16_f32 v165, 0, v165
    v_cvt_pk_bf16_f32 v166, 0, v166
    v_cvt_pk_bf16_f32 v167, 0, v167
    v_mul_f32 v152, s44, v152
    v_mul_f32 v160, s45, v160
    v_cvt_pk_bf16_f32 v128, v152, v160
    v_mul_f32 v153, s44, v153
    v_mul_f32 v161, s45, v161
    v_cvt_pk_bf16_f32 v129, v153, v161
    v_mul_f32 v154, s44, v154
    v_mul_f32 v162, s45, v162
    v_cvt_pk_bf16_f32 v130, v154, v162
    v_mul_f32 v155, s44, v155
    v_mul_f32 v163, s45, v163
    v_cvt_pk_bf16_f32 v131, v155, v163
    ds_write_b128 v168, v[128:131]
    v_mul_f32 v156, s44, v156
    v_mul_f32 v164, s45, v164
    v_cvt_pk_bf16_f32 v132, v156, v164
    v_mul_f32 v157, s44, v157
    v_mul_f32 v165, s45, v165
    v_cvt_pk_bf16_f32 v133, v157, v165
    v_mul_f32 v158, s44, v158
    v_mul_f32 v166, s45, v166
    v_cvt_pk_bf16_f32 v134, v158, v166
    v_mul_f32 v159, s44, v159
    v_mul_f32 v167, s45, v167
    v_cvt_pk_bf16_f32 v135, v159, v167
    ds_write_b128 v168, v[132:135] offset:16
    s_waitcnt lgkmcnt(0)
    s_barrier
    ds_read2st64_b32 v[120:121], v169 offset0:0 offset1:8
    ds_read2st64_b32 v[122:123], v169 offset0:16 offset1:24
    ds_read2st64_b32 v[124:125], v169 offset0:4 offset1:12
    ds_read2st64_b32 v[126:127], v169 offset0:20 offset1:28
    s_mul_i32 s39, s39, 1664525
    s_add_u32 s39, s39, 1013904223
    v_mov_b32 v32, s39
    s_add_u32 s70, s39, 28
    s_waitcnt vmcnt(4)
    s_cmp_lg_u32 s71, 0
    s_cbranch_scc1 L_noinit
    s_mov_b64 exec, 1
    global_store_dword v185, v32, s[18:19] sc1
    s_mov_b64 exec, -1
L_noinit:
    s_waitcnt lgkmcnt(2)
    global_store_dwordx4 v170, v[120:123], s[18:19] sc1
    s_waitcnt lgkmcnt(0)
    global_store_dwordx4 v171, v[124:127], s[18:19] sc1
    s_cmp_ge_u32 s2, 224
    s_cbranch_scc1 L_idle2
    s_add_u32 m0, s36, 8192
    s_add_u32 s40, s52, 1
    s_and_b32 s40, s40, 7
    s_mul_i32 s40, s40, 229376
    s_add_u32 s37, s53, s40
    buffer_load_dwordx4 v3, s[20:23], s37 offen offset:0 lds
    ds_read_b64_tr_b16 a[0:1], v11 offset:0
    ds_read_b64_tr_b16 a[2:3], v11 offset:512
    ds_read_b64_tr_b16 a[4:5], v12 offset:0
    buffer_load_dwordx4 v4, s[20:23], s37 offen offset:1024 lds
    ds_read_b64_tr_b16 a[6:7], v12 offset:512
    ds_read_b64_tr_b16 a[8:9], v13 offset:0
    ds_read_b64_tr_b16 a[10:11], v13 offset:512
    buffer_load_dwordx4 v5, s[20:23], s37 offen offset:2048 lds
    ds_read_b64_tr_b16 a[12:13], v14 offset:0
    ds_read_b64_tr_b16 a[14:15], v14 offset:512
    buffer_load_dwordx4 v6, s[20:23], s37 offen offset:3072 lds
    v_lshlrev_b32 v40, 16, v48
    v_and_b32 v41, s47, v48
    v_lshlrev_b32 v42, 16, v49
    v_and_b32 v43, s47, v49
    v_lshlrev_b32 v44, 16, v50
    v_and_b32 v45, s47, v50
    v_lshlrev_b32 v46, 16, v51
    v_and_b32 v47, s47, v51
    v_lshlrev_b32 v182, 16, v25
    v_lshlrev_b32 v183, 16, v25
    s_add_u32 m0, s36, 12288
    s_add_u32 s37, s37, 114688
    buffer_load_dwordx4 v3, s[20:23], s37 offen offset:0 lds
    buffer_load_dwordx4 v4, s[20:23], s37 offen offset:1024 lds
    buffer_load_dwordx4 v5, s[20:23], s37 offen offset:2048 lds
    buffer_load_dwordx4 v6, s[20:23], s37 offen offset:3072 lds
    s_add_u32 m0, s36, 16384
    s_add_u32 s40, s52, 2
    s_and_b32 s40, s40, 7
    s_mul_i32 s40, s40, 229376
    s_add_u32 s37, s53, s40
    buffer_load_dwordx4 v3, s[20:23], s37 offen offset:0 lds
    s_waitcnt vmcnt(9)
    s_atomic_swap s39, s[18:19], s66
    ds_read_b64_tr_b16 a[16:17], v11 offset:4096
    ds_read_b64_tr_b16 a[18:19], v11 offset:4608
    ds_read_b64_tr_b16 a[20:21], v12 offset:4096
    buffer_load_dwordx4 v4, s[20:23], s37 offen offset:1024 lds
    ds_read_b64_tr_b16 a[22:23], v12 offset:4608
    ds_read_b64_tr_b16 a[24:25], v13 offset:4096
    ds_read_b64_tr_b16 a[26:27], v13 offset:4608
    buffer_load_dwordx4 v5, s[20:23], s37 offen offset:2048 lds
    ds_read_b64_tr_b16 a[28:29], v14 offset:4096
    ds_read_b64_tr_b16 a[30:31], v14 offset:4608
    buffer_load_dwordx4 v6, s[20:23], s37 offen offset:3072 lds
    s_add_u32 m0, s36, 20480
    s_add_u32 s37, s37, 114688
    buffer_load_dwordx4 v3, s[20:23], s37 offen offset:0 lds
    buffer_load_dwordx4 v4, s[20:23], s37 offen offset:1024 lds
    buffer_load_dwordx4 v5, s[20:23], s37 offen offset:2048 lds
    buffer_load_dwordx4 v6, s[20:23], s37 offen offset:3072 lds
    s_waitcnt vmcnt(12)
    ds_read_b64_tr_b16 a[32:33], v11 offset:8192
    ds_read_b64_tr_b16 a[34:35], v11 offset:8704
    ds_read_b64_tr_b16 a[36:37], v12 offset:8192
    s_add_u32 m0, s36, 24576
    s_add_u32 s40, s52, 3
    s_and_b32 s40, s40, 7
    s_mul_i32 s40, s40, 229376
    s_add_u32 s37, s53, s40
    buffer_load_dwordx4 v3, s[20:23], s37 offen offset:0 lds
    ds_read_b64_tr_b16 a[38:39], v12 offset:8704
    ds_read_b64_tr_b16 a[40:41], v13 offset:8192
    ds_read_b64_tr_b16 a[42:43], v13 offset:8704
    buffer_load_dwordx4 v4, s[20:23], s37 offen offset:1024 lds
    ds_read_b64_tr_b16 a[44:45], v14 offset:8192
    ds_read_b64_tr_b16 a[46:47], v14 offset:8704
    buffer_load_dwordx4 v5, s[20:23], s37 offen offset:2048 lds
    buffer_load_dwordx4 v6, s[20:23], s37 offen offset:3072 lds
    s_waitcnt vmcnt(12)
    ds_read_b64_tr_b16 a[48:49], v11 offset:12288
    ds_read_b64_tr_b16 a[50:51], v11 offset:12800
    ds_read_b64_tr_b16 a[52:53], v12 offset:12288
    s_waitcnt lgkmcnt(15)
    s_add_u32 m0, s36, 0
    s_add_u32 s37, s37, 114688
    buffer_load_dwordx4 v3, s[20:23], s37 offen offset:0 lds
    ds_read_b64_tr_b16 a[54:55], v12 offset:12800
    ds_read_b64_tr_b16 a[56:57], v13 offset:12288
    ds_read_b64_tr_b16 a[58:59], v13 offset:12800
    buffer_load_dwordx4 v4, s[20:23], s37 offen offset:1024 lds
    ds_read_b64_tr_b16 a[60:61], v14 offset:12288
    ds_read_b64_tr_b16 a[62:63], v14 offset:12800
    buffer_load_dwordx4 v5, s[20:23], s37 offen offset:2048 lds
    buffer_load_dwordx4 v6, s[20:23], s37 offen offset:3072 lds
    s_waitcnt vmcnt(12)
    ds_read_b64_tr_b16 a[64:65], v11 offset:16384
    ds_read_b64_tr_b16 a[66:67], v11 offset:16896
    ds_read_b64_tr_b16 a[68:69], v12 offset:16384
    s_waitcnt lgkmcnt(15)
    s_add_u32 m0, s36, 4096
    s_add_u32 s40, s52, 4
    s_and_b32 s40, s40, 7
    s_mul_i32 s40, s40, 229376
    s_add_u32 s37, s53, s40
    buffer_load_dwordx4 v3, s[20:23], s37 offen offset:0 lds
    ds_read_b64_tr_b16 a[70:71], v12 offset:16896
    ds_read_b64_tr_b16 a[72:73], v13 offset:16384
    ds_read_b64_tr_b16 a[74:75], v13 offset:16896
    buffer_load_dwordx4 v4, s[20:23], s37 offen offset:1024 lds
    ds_read_b64_tr_b16 a[76:77], v14 offset:16384
    ds_read_b64_tr_b16 a[78:79], v14 offset:16896
    buffer_load_dwordx4 v5, s[20:23], s37 offen offset:2048 lds
    buffer_load_dwordx4 v6, s[20:23], s37 offen offset:3072 lds
    s_waitcnt vmcnt(12)
    ds_read_b64_tr_b16 a[80:81], v11 offset:20480
    ds_read_b64_tr_b16 a[82:83], v11 offset:20992
    ds_read_b64_tr_b16 a[84:85], v12 offset:20480
    s_waitcnt lgkmcnt(15)
    s_add_u32 m0, s36, 8192
    s_add_u32 s37, s37, 114688
    buffer_load_dwordx4 v3, s[20:23], s37 offen offset:0 lds
    ds_read_b64_tr_b16 a[86:87], v12 offset:20992
    ds_read_b64_tr_b16 a[88:89], v13 offset:20480
    ds_read_b64_tr_b16 a[90:91], v13 offset:20992
    buffer_load_dwordx4 v4, s[20:23], s37 offen offset:1024 lds
    ds_read_b64_tr_b16 a[92:93], v14 offset:20480
    ds_read_b64_tr_b16 a[94:95], v14 offset:20992
    buffer_load_dwordx4 v5, s[20:23], s37 offen offset:2048 lds
    buffer_load_dwordx4 v6, s[20:23], s37 offen offset:3072 lds
    s_waitcnt vmcnt(12)
    ds_read_b64_tr_b16 a[96:97], v11 offset:24576
    ds_read_b64_tr_b16 a[98:99], v11 offset:25088
    ds_read_b64_tr_b16 a[100:101], v12 offset:24576
    s_waitcnt lgkmcnt(15)
    s_add_u32 m0, s36, 12288
    s_add_u32 s40, s52, 5
    s_and_b32 s40, s40, 7
    s_mul_i32 s40, s40, 229376
    s_add_u32 s37, s53, s40
    buffer_load_dwordx4 v3, s[20:23], s37 offen offset:0 lds
    ds_read_b64_tr_b16 a[102:103], v12 offset:25088
    ds_read_b64_tr_b16 a[104:105], v13 offset:24576
    ds_read_b64_tr_b16 a[106:107], v13 offset:25088
    buffer_load_dwordx4 v4, s[20:23], s37 offen offset:1024 lds
    ds_read_b64_tr_b16 a[108:109], v14 offset:24576
    ds_read_b64_tr_b16 a[110:111], v14 offset:25088
    buffer_load_dwordx4 v5, s[20:23], s37 offen offset:2048 lds
    buffer_load_dwordx4 v6, s[20:23], s37 offen offset:3072 lds
    s_waitcnt vmcnt(12)
    ds_read_b64_tr_b16 a[112:113], v11 offset:0
    ds_read_b64_tr_b16 a[114:115], v11 offset:512
    ds_read_b64_tr_b16 a[116:117], v12 offset:0
    s_waitcnt lgkmcnt(15)
    s_add_u32 m0, s36, 16384
    s_add_u32 s37, s37, 114688
    buffer_load_dwordx4 v3, s[20:23], s37 offen offset:0 lds
    ds_read_b64_tr_b16 a[118:119], v12 offset:512
    ds_read_b64_tr_b16 a[120:121], v13 offset:0
    ds_read_b64_tr_b16 a[122:123], v13 offset:512
    buffer_load_dwordx4 v4, s[20:23], s37 offen offset:1024 lds
    ds_read_b64_tr_b16 a[124:125], v14 offset:0
    ds_read_b64_tr_b16 a[126:127], v14 offset:512
    buffer_load_dwordx4 v5, s[20:23], s37 offen offset:2048 lds
    buffer_load_dwordx4 v6, s[20:23], s37 offen offset:3072 lds
    s_waitcnt vmcnt(12)
    ds_read_b64_tr_b16 a[128:129], v11 offset:4096
    ds_read_b64_tr_b16 a[130:131], v11 offset:4608
    ds_read_b64_tr_b16 a[132:133], v12 offset:4096
    s_waitcnt lgkmcnt(15)
    s_add_u32 m0, s36, 20480
    s_add_u32 s40, s52, 6
    s_and_b32 s40, s40, 7
    s_mul_i32 s40, s40, 229376
    s_add_u32 s37, s53, s40
    buffer_load_dwordx4 v3, s[20:23], s37 offen offset:0 lds
    ds_read_b64_tr_b16 a[134:135], v12 offset:4608
    ds_read_b64_tr_b16 a[136:137], v13 offset:4096
    ds_read_b64_tr_b16 a[138:139], v13 offset:4608
    buffer_load_dwordx4 v4, s[20:23], s37 offen offset:1024 lds
    ds_read_b64_tr_b16 a[140:141], v14 offset:4096
    ds_read_b64_tr_b16 a[142:143], v14 offset:4608
    buffer_load_dwordx4 v5, s[20:23], s37 offen offset:2048 lds
    buffer_load_dwordx4 v6, s[20:23], s37 offen offset:3072 lds
    s_waitcnt vmcnt(12)
    ds_read_b64_tr_b16 a[144:145], v11 offset:8192
    ds_read_b64_tr_b16 a[146:147], v11 offset:8704
    ds_read_b64_tr_b16 a[148:149], v12 offset:8192
    global_load_dword v26, v22, s[18:19] sc1
    s_waitcnt lgkmcnt(15)
    s_add_u32 m0, s36, 24576
    s_add_u32 s37, s37, 114688
    buffer_load_dwordx4 v3, s[20:23], s37 offen offset:0 lds
    ds_read_b64_tr_b16 a[150:151], v12 offset:8704
    ds_read_b64_tr_b16 a[152:153], v13 offset:8192
    ds_read_b64_tr_b16 a[154:155], v13 offset:8704
    buffer_load_dwordx4 v4, s[20:23], s37 offen offset:1024 lds
    ds_read_b64_tr_b16 a[156:157], v14 offset:8192
    ds_read_b64_tr_b16 a[158:159], v14 offset:8704
    buffer_load_dwordx4 v5, s[20:23], s37 offen offset:2048 lds
    s_waitcnt vmcnt(12)
    ds_read_b64_tr_b16 a[160:161], v11 offset:12288
    ds_read_b64_tr_b16 a[162:163], v11 offset:12800
    ds_read_b64_tr_b16 a[164:165], v12 offset:12288
    buffer_load_dwordx4 v6, s[20:23], s37 offen offset:3072 lds
    ds_read_b64_tr_b16 a[166:167], v12 offset:12800
    ds_read_b64_tr_b16 a[168:169], v13 offset:12288
    ds_read_b64_tr_b16 a[170:171], v13 offset:12800
    s_waitcnt lgkmcnt(15)
    s_add_u32 m0, s36, 0
    s_add_u32 s40, s52, 7
    s_and_b32 s40, s40, 7
    s_mul_i32 s40, s40, 229376
    s_add_u32 s37, s53, s40
    buffer_load_dwordx4 v3, s[20:23], s37 offen offset:0 lds
    ds_read_b64_tr_b16 a[172:173], v14 offset:12288
    ds_read_b64_tr_b16 a[174:175], v14 offset:12800
    buffer_load_dwordx4 v4, s[20:23], s37 offen offset:1024 lds
    buffer_load_dwordx4 v5, s[20:23], s37 offen offset:2048 lds
    s_waitcnt vmcnt(12)
    ds_read_b64_tr_b16 a[176:177], v11 offset:16384
    ds_read_b64_tr_b16 a[178:179], v11 offset:16896
    ds_read_b64_tr_b16 a[180:181], v12 offset:16384
    buffer_load_dwordx4 v6, s[20:23], s37 offen offset:3072 lds
    ds_read_b64_tr_b16 a[182:183], v12 offset:16896
    ds_read_b64_tr_b16 a[184:185], v13 offset:16384
    ds_read_b64_tr_b16 a[186:187], v13 offset:16896
    s_waitcnt lgkmcnt(15)
    s_add_u32 m0, s36, 4096
    s_add_u32 s37, s37, 114688
    buffer_load_dwordx4 v3, s[20:23], s37 offen offset:0 lds
    ds_read_b64_tr_b16 a[188:189], v14 offset:16384
    ds_read_b64_tr_b16 a[190:191], v14 offset:16896
    buffer_load_dwordx4 v4, s[20:23], s37 offen offset:1024 lds
    buffer_load_dwordx4 v5, s[20:23], s37 offen offset:2048 lds
    s_waitcnt vmcnt(12)
    ds_read_b64_tr_b16 a[192:193], v11 offset:20480
    ds_read_b64_tr_b16 a[194:195], v11 offset:20992
    ds_read_b64_tr_b16 a[196:197], v12 offset:20480
    buffer_load_dwordx4 v6, s[20:23], s37 offen offset:3072 lds
    ds_read_b64_tr_b16 a[198:199], v12 offset:20992
    ds_read_b64_tr_b16 a[200:201], v13 offset:20480
    ds_read_b64_tr_b16 a[202:203], v13 offset:20992
    s_waitcnt vmcnt(12)
    v_cmp_ne_u32 vcc, s39, v26
    s_cbranch_vccz L_poll1_ok
    s_mov_b32 s40, 0x20000
L_poll1:
    s_sleep 3
    global_load_dword v26, v22, s[18:19] sc1
    s_waitcnt vmcnt(0)
    v_cmp_ne_u32 vcc, s39, v26
    s_cbranch_vccz L_poll1_ok
    s_sub_u32 s40, s40, 1
    s_cbranch_scc0 L_poll1
L_poll1_ok:
    s_mov_b32 s55, s54
    s_lshl_b32 s41, s52, 12
    s_or_b32 s38, s55, s41
    buffer_load_dwordx4 v[96:99], v20, s[28:31], s38 offen offset:0 sc1
    ds_read_b64_tr_b16 a[204:205], v14 offset:20480
    ds_read_b64_tr_b16 a[206:207], v14 offset:20992
    buffer_load_dwordx4 v[100:103], v21, s[28:31], s38 offen offset:0 sc1
    buffer_load_dwordx4 v[104:107], v20, s[28:31], s38 offen offset:2048 sc1
    buffer_load_dwordx4 v[108:111], v21, s[28:31], s38 offen offset:2048 sc1
    s_waitcnt vmcnt(12)
    ds_read_b64_tr_b16 a[208:209], v11 offset:24576
    ds_read_b64_tr_b16 a[210:211], v11 offset:25088
    s_add_u32 s41, s38, 4096
    s_and_b32 s41, s41, 0x7fff
    s_or_b32 s38, s55, s41
    buffer_load_dwordx4 v[112:115], v20, s[28:31], s38 offen offset:0 sc1
    ds_read_b64_tr_b16 a[212:213], v12 offset:24576
    ds_read_b64_tr_b16 a[214:215], v12 offset:25088
    buffer_load_dwordx4 v[116:119], v21, s[28:31], s38 offen offset:0 sc1
    ds_read_b64_tr_b16 a[216:217], v13 offset:24576
    ds_read_b64_tr_b16 a[218:219], v13 offset:25088
    buffer_load_dwordx4 v[120:123], v20, s[28:31], s38 offen offset:2048 sc1
    ds_read_b64_tr_b16 a[220:221], v14 offset:24576
    ds_read_b64_tr_b16 a[222:223], v14 offset:25088
    buffer_load_dwordx4 v[124:127], v21, s[28:31], s38 offen offset:2048 sc1
    s_waitcnt vmcnt(12)
    ds_read_b64_tr_b16 a[224:225], v11 offset:0
    ds_read_b64_tr_b16 a[226:227], v11 offset:512
    s_add_u32 s41, s38, 4096
    s_and_b32 s41, s41, 0x7fff
    s_or_b32 s38, s55, s41
    buffer_load_dwordx4 v[128:131], v20, s[28:31], s38 offen offset:0 sc1
    ds_read_b64_tr_b16 a[228:229], v12 offset:0
    ds_read_b64_tr_b16 a[230:231], v12 offset:512
    buffer_load_dwordx4 v[132:135], v21, s[28:31], s38 offen offset:0 sc1
    ds_read_b64_tr_b16 a[232:233], v13 offset:0
    ds_read_b64_tr_b16 a[234:235], v13 offset:512
    buffer_load_dwordx4 v[136:139], v20, s[28:31], s38 offen offset:2048 sc1
    ds_read_b64_tr_b16 a[236:237], v14 offset:0
    ds_read_b64_tr_b16 a[238:239], v14 offset:512
    buffer_load_dwordx4 v[140:143], v21, s[28:31], s38 offen offset:2048 sc1
    s_waitcnt vmcnt(12)
    ds_read_b64_tr_b16 a[240:241], v11 offset:4096
    ds_read_b64_tr_b16 a[242:243], v11 offset:4608
    s_waitcnt vmcnt(11)
    v_mfma_f32_16x16x32_bf16 v[192:195], a[0:3], v[96:99], 0
    s_add_u32 s41, s38, 4096
    s_and_b32 s41, s41, 0x7fff
    s_or_b32 s38, s55, s41
    buffer_load_dwordx4 v[144:147], v20, s[28:31], s38 offen offset:0 sc1
    ds_read_b64_tr_b16 a[244:245], v12 offset:4096
    v_mfma_f32_16x16x32_bf16 v[196:199], a[4:7], v[96:99], 0
    ds_read_b64_tr_b16 a[246:247], v12 offset:4608
    v_mfma_f32_16x16x32_bf16 v[200:203], a[8:11], v[96:99], 0
    ds_read_b64_tr_b16 a[248:249], v13 offset:4096
    v_mfma_f32_16x16x32_bf16 v[204:207], a[12:15], v[96:99], 0
    ds_read_b64_tr_b16 a[250:251], v13 offset:4608
    s_waitcnt vmcnt(11)
    v_mfma_f32_16x16x32_bf16 v[208:211], a[0:3], v[100:103], 0
    buffer_load_dwordx4 v[148:151], v21, s[28:31], s38 offen offset:0 sc1
    ds_read_b64_tr_b16 a[252:253], v14 offset:4096
    v_mfma_f32_16x16x32_bf16 v[212:215], a[4:7], v[100:103], 0
    ds_read_b64_tr_b16 a[254:255], v14 offset:4608
    v_mfma_f32_16x16x32_bf16 v[216:219], a[8:11], v[100:103], 0
    v_mfma_f32_16x16x32_bf16 v[220:223], a[12:15], v[100:103], 0
    s_waitcnt vmcnt(11)
    v_mfma_f32_16x16x32_bf16 v[192:195], a[16:19], v[104:107], v[192:195]
    buffer_load_dwordx4 v[152:155], v20, s[28:31], s38 offen offset:2048 sc1
    v_mfma_f32_16x16x32_bf16 v[196:199], a[20:23], v[104:107], v[196:199]
    v_mfma_f32_16x16x32_bf16 v[200:203], a[24:27], v[104:107], v[200:203]
    v_mfma_f32_16x16x32_bf16 v[204:207], a[28:31], v[104:107], v[204:207]
    s_waitcnt vmcnt(11)
    v_mfma_f32_16x16x32_bf16 v[208:211], a[16:19], v[108:111], v[208:211]
    buffer_load_dwordx4 v[156:159], v21, s[28:31], s38 offen offset:2048 sc1
    v_mfma_f32_16x16x32_bf16 v[212:215], a[20:23], v[108:111], v[212:215]
    v_mfma_f32_16x16x32_bf16 v[216:219], a[24:27], v[108:111], v[216:219]
    v_mfma_f32_16x16x32_bf16 v[220:223], a[28:31], v[108:111], v[220:223]
    s_waitcnt vmcnt(11)
    v_mfma_f32_16x16x32_bf16 v[192:195], a[32:35], v[112:115], v[192:195]
    s_add_u32 s41, s38, 4096
    s_and_b32 s41, s41, 0x7fff
    s_or_b32 s38, s55, s41
    buffer_load_dwordx4 v[160:163], v20, s[28:31], s38 offen offset:0 sc1
    v_mfma_f32_16x16x32_bf16 v[196:199], a[36:39], v[112:115], v[196:199]
    v_mfma_f32_16x16x32_bf16 v[200:203], a[40:43], v[112:115], v[200:203]
    v_mfma_f32_16x16x32_bf16 v[204:207], a[44:47], v[112:115], v[204:207]
    s_waitcnt vmcnt(11)
    v_mfma_f32_16x16x32_bf16 v[208:211], a[32:35], v[116:119], v[208:211]
    buffer_load_dwordx4 v[164:167], v21, s[28:31], s38 offen offset:0 sc1
    v_mfma_f32_16x16x32_bf16 v[212:215], a[36:39], v[116:119], v[212:215]
    v_mfma_f32_16x16x32_bf16 v[216:219], a[40:43], v[116:119], v[216:219]
    v_mfma_f32_16x16x32_bf16 v[220:223], a[44:47], v[116:119], v[220:223]
    s_waitcnt vmcnt(11)
    v_mfma_f32_16x16x32_bf16 v[192:195], a[48:51], v[120:123], v[192:195]
    buffer_load_dwordx4 v[168:171], v20, s[28:31], s38 offen offset:2048 sc1
    v_mfma_f32_16x16x32_bf16 v[196:199], a[52:55], v[120:123], v[196:199]
    v_mfma_f32_16x16x32_bf16 v[200:203], a[56:59], v[120:123], v[200:203]
    v_mfma_f32_16x16x32_bf16 v[204:207], a[60:63], v[120:123], v[204:207]
    s_waitcnt vmcnt(11)
    v_mfma_f32_16x16x32_bf16 v[208:211], a[48:51], v[124:127], v[208:211]
    buffer_load_dwordx4 v[172:175], v21, s[28:31], s38 offen offset:2048 sc1
    v_mfma_f32_16x16x32_bf16 v[212:215], a[52:55], v[124:127], v[212:215]
    v_mfma_f32_16x16x32_bf16 v[216:219], a[56:59], v[124:127], v[216:219]
    v_mfma_f32_16x16x32_bf16 v[220:223], a[60:63], v[124:127], v[220:223]
    s_waitcnt vmcnt(11)
    v_mfma_f32_16x16x32_bf16 v[192:195], a[64:67], v[128:131], v[192:195]
    s_add_u32 s41, s38, 4096
    s_and_b32 s41, s41, 0x7fff
    s_or_b32 s38, s55, s41
    buffer_load_dwordx4 v[96:99], v20, s[28:31], s38 offen offset:0 sc1
    v_mfma_f32_16x16x32_bf16 v[196:199], a[68:71], v[128:131], v[196:199]
    v_mfma_f32_16x16x32_bf16 v[200:203], a[72:75], v[128:131], v[200:203]
    v_mfma_f32_16x16x32_bf16 v[204:207], a[76:79], v[128:131], v[204:207]
    s_waitcnt vmcnt(11)
    v_mfma_f32_16x16x32_bf16 v[208:211], a[64:67], v[132:135], v[208:211]
    buffer_load_dwordx4 v[100:103], v21, s[28:31], s38 offen offset:0 sc1
    v_mfma_f32_16x16x32_bf16 v[212:215], a[68:71], v[132:135], v[212:215]
    v_mfma_f32_16x16x32_bf16 v[216:219], a[72:75], v[132:135], v[216:219]
    v_mfma_f32_16x16x32_bf16 v[220:223], a[76:79], v[132:135], v[220:223]
    s_waitcnt vmcnt(11)
    v_mfma_f32_16x16x32_bf16 v[192:195], a[80:83], v[136:139], v[192:195]
    buffer_load_dwordx4 v[104:107], v20, s[28:31], s38 offen offset:2048 sc1
    v_mfma_f32_16x16x32_bf16 v[196:199], a[84:87], v[136:139], v[196:199]
    v_mfma_f32_16x16x32_bf16 v[200:203], a[88:91], v[136:139], v[200:203]
    v_mfma_f32_16x16x32_bf16 v[204:207], a[92:95], v[136:139], v[204:207]
    s_waitcnt vmcnt(11)
    v_mfma_f32_16x16x32_bf16 v[208:211], a[80:83], v[140:143], v[208:211]
    buffer_load_dwordx4 v[108:111], v21, s[28:31], s38 offen offset:2048 sc1
    v_mfma_f32_16x16x32_bf16 v[212:215], a[84:87], v[140:143], v[212:215]
    v_mfma_f32_16x16x32_bf16 v[216:219], a[88:91], v[140:143], v[216:219]
    v_mfma_f32_16x16x32_bf16 v[220:223], a[92:95], v[140:143], v[220:223]
    s_waitcnt vmcnt(11)
    v_mfma_f32_16x16x32_bf16 v[192:195], a[96:99], v[144:147], v[192:195]
    s_add_u32 s41, s38, 4096
    s_and_b32 s41, s41, 0x7fff
    s_or_b32 s38, s55, s41
    buffer_load_dwordx4 v[112:115], v20, s[28:31], s38 offen offset:0 sc1
    v_mfma_f32_16x16x32_bf16 v[196:199], a[100:103], v[144:147], v[196:199]
    v_mfma_f32_16x16x32_bf16 v[200:203], a[104:107], v[144:147], v[200:203]
    v_mfma_f32_16x16x32_bf16 v[204:207], a[108:111], v[144:147], v[204:207]
    s_waitcnt vmcnt(11)
    v_mfma_f32_16x16x32_bf16 v[208:211], a[96:99], v[148:151], v[208:211]
    buffer_load_dwordx4 v[116:119], v21, s[28:31], s38 offen offset:0 sc1
    v_mfma_f32_16x16x32_bf16 v[212:215], a[100:103], v[148:151], v[212:215]
    v_mfma_f32_16x16x32_bf16 v[216:219], a[104:107], v[148:151], v[216:219]
    v_mfma_f32_16x16x32_bf16 v[220:223], a[108:111], v[148:151], v[220:223]
    s_waitcnt vmcnt(11)
    v_mfma_f32_16x16x32_bf16 v[192:195], a[112:115], v[152:155], v[192:195]
    buffer_load_dwordx4 v[120:123], v20, s[28:31], s38 offen offset:2048 sc1
    v_mfma_f32_16x16x32_bf16 v[196:199], a[116:119], v[152:155], v[196:199]
    v_mfma_f32_16x16x32_bf16 v[200:203], a[120:123], v[152:155], v[200:203]
    v_mfma_f32_16x16x32_bf16 v[204:207], a[124:127], v[152:155], v[204:207]
    s_waitcnt vmcnt(11)
    v_mfma_f32_16x16x32_bf16 v[208:211], a[112:115], v[156:159], v[208:211]
    buffer_load_dwordx4 v[124:127], v21, s[28:31], s38 offen offset:2048 sc1
    v_mfma_f32_16x16x32_bf16 v[212:215], a[116:119], v[156:159], v[212:215]
    v_mfma_f32_16x16x32_bf16 v[216:219], a[120:123], v[156:159], v[216:219]
    v_mfma_f32_16x16x32_bf16 v[220:223], a[124:127], v[156:159], v[220:223]
    s_waitcnt vmcnt(11)
    v_mfma_f32_16x16x32_bf16 v[192:195], a[128:131], v[160:163], v[192:195]
    s_add_u32 s41, s38, 4096
    s_and_b32 s41, s41, 0x7fff
    s_or_b32 s38, s55, s41
    buffer_load_dwordx4 v[128:131], v20, s[28:31], s38 offen offset:0 sc1
    v_mfma_f32_16x16x32_bf16 v[196:199], a[132:135], v[160:163], v[196:199]
    v_mfma_f32_16x16x32_bf16 v[200:203], a[136:139], v[160:163], v[200:203]
    v_mfma_f32_16x16x32_bf16 v[204:207], a[140:143], v[160:163], v[204:207]
    s_waitcnt vmcnt(11)
    v_mfma_f32_16x16x32_bf16 v[208:211], a[128:131], v[164:167], v[208:211]
    buffer_load_dwordx4 v[132:135], v21, s[28:31], s38 offen offset:0 sc1
    v_mfma_f32_16x16x32_bf16 v[212:215], a[132:135], v[164:167], v[212:215]
    v_mfma_f32_16x16x32_bf16 v[216:219], a[136:139], v[164:167], v[216:219]
    v_mfma_f32_16x16x32_bf16 v[220:223], a[140:143], v[164:167], v[220:223]
    s_waitcnt lgkmcnt(15)
    s_waitcnt vmcnt(11)
    v_mfma_f32_16x16x32_bf16 v[192:195], a[144:147], v[168:171], v[192:195]
    buffer_load_dwordx4 v[136:139], v20, s[28:31], s38 offen offset:2048 sc1
    v_mfma_f32_16x16x32_bf16 v[196:199], a[148:151], v[168:171], v[196:199]
    v_mfma_f32_16x16x32_bf16 v[200:203], a[152:155], v[168:171], v[200:203]
    v_mfma_f32_16x16x32_bf16 v[204:207], a[156:159], v[168:171], v[204:207]
    s_waitcnt vmcnt(11)
    v_mfma_f32_16x16x32_bf16 v[208:211], a[144:147], v[172:175], v[208:211]
    buffer_load_dwordx4 v[140:143], v21, s[28:31], s38 offen offset:2048 sc1
    v_mfma_f32_16x16x32_bf16 v[212:215], a[148:151], v[172:175], v[212:215]
    v_mfma_f32_16x16x32_bf16 v[216:219], a[152:155], v[172:175], v[216:219]
    v_mfma_f32_16x16x32_bf16 v[220:223], a[156:159], v[172:175], v[220:223]
    s_waitcnt vmcnt(11)
    v_mfma_f32_16x16x32_bf16 v[192:195], a[160:163], v[96:99], v[192:195]
    s_xor_b32 s55, s54, 131072
    s_lshl_b32 s41, s52, 12
    s_or_b32 s38, s55, s41
    buffer_load_dwordx4 v[144:147], v20, s[28:31], s38 offen offset:0 sc1
    v_mfma_f32_16x16x32_bf16 v[196:199], a[164:167], v[96:99], v[196:199]
    v_mfma_f32_16x16x32_bf16 v[200:203], a[168:171], v[96:99], v[200:203]
    v_mfma_f32_16x16x32_bf16 v[204:207], a[172:175], v[96:99], v[204:207]
    s_waitcnt vmcnt(11)
    v_mfma_f32_16x16x32_bf16 v[208:211], a[160:163], v[100:103], v[208:211]
    buffer_load_dwordx4 v[148:151], v21, s[28:31], s38 offen offset:0 sc1
    v_mfma_f32_16x16x32_bf16 v[212:215], a[164:167], v[100:103], v[212:215]
    v_mfma_f32_16x16x32_bf16 v[216:219], a[168:171], v[100:103], v[216:219]
    v_mfma_f32_16x16x32_bf16 v[220:223], a[172:175], v[100:103], v[220:223]
    s_waitcnt vmcnt(11)
    v_mfma_f32_16x16x32_bf16 v[192:195], a[176:179], v[104:107], v[192:195]
    buffer_load_dwordx4 v[152:155], v20, s[28:31], s38 offen offset:2048 sc1
    v_mfma_f32_16x16x32_bf16 v[196:199], a[180:183], v[104:107], v[196:199]
    v_mfma_f32_16x16x32_bf16 v[200:203], a[184:187], v[104:107], v[200:203]
    v_mfma_f32_16x16x32_bf16 v[204:207], a[188:191], v[104:107], v[204:207]
    s_waitcnt vmcnt(11)
    v_mfma_f32_16x16x32_bf16 v[208:211], a[176:179], v[108:111], v[208:211]
    buffer_load_dwordx4 v[156:159], v21, s[28:31], s38 offen offset:2048 sc1
    v_mfma_f32_16x16x32_bf16 v[212:215], a[180:183], v[108:111], v[212:215]
    v_mfma_f32_16x16x32_bf16 v[216:219], a[184:187], v[108:111], v[216:219]
    v_mfma_f32_16x16x32_bf16 v[220:223], a[188:191], v[108:111], v[220:223]
    s_waitcnt vmcnt(11)
    v_mfma_f32_16x16x32_bf16 v[192:195], a[192:195], v[112:115], v[192:195]
    s_add_u32 s41, s38, 4096
    s_and_b32 s41, s41, 0x7fff
    s_or_b32 s38, s55, s41
    buffer_load_dwordx4 v[160:163], v20, s[28:31], s38 offen offset:0 sc1
    v_mfma_f32_16x16x32_bf16 v[196:199], a[196:199], v[112:115], v[196:199]
    v_mfma_f32_16x16x32_bf16 v[200:203], a[200:203], v[112:115], v[200:203]
    v_mfma_f32_16x16x32_bf16 v[204:207], a[204:207], v[112:115], v[204:207]
    s_waitcnt vmcnt(11)
    v_mfma_f32_16x16x32_bf16 v[208:211], a[192:195], v[116:119], v[208:211]
    buffer_load_dwordx4 v[164:167], v21, s[28:31], s38 offen offset:0 sc1
    v_mfma_f32_16x16x32_bf16 v[212:215], a[196:199], v[116:119], v[212:215]
    v_mfma_f32_16x16x32_bf16 v[216:219], a[200:203], v[116:119], v[216:219]
    v_mfma_f32_16x16x32_bf16 v[220:223], a[204:207], v[116:119], v[220:223]
    s_waitcnt vmcnt(11)
    v_mfma_f32_16x16x32_bf16 v[192:195], a[208:211], v[120:123], v[192:195]
    buffer_load_dwordx4 v[168:171], v20, s[28:31], s38 offen offset:2048 sc1
    v_mfma_f32_16x16x32_bf16 v[196:199], a[212:215], v[120:123], v[196:199]
    v_mfma_f32_16x16x32_bf16 v[200:203], a[216:219], v[120:123], v[200:203]
    v_mfma_f32_16x16x32_bf16 v[204:207], a[220:223], v[120:123], v[204:207]
    s_waitcnt vmcnt(11)
    v_mfma_f32_16x16x32_bf16 v[208:211], a[208:211], v[124:127], v[208:211]
    buffer_load_dwordx4 v[172:175], v21, s[28:31], s38 offen offset:2048 sc1
    v_mfma_f32_16x16x32_bf16 v[212:215], a[212:215], v[124:127], v[212:215]
    v_mfma_f32_16x16x32_bf16 v[216:219], a[216:219], v[124:127], v[216:219]
    v_mfma_f32_16x16x32_bf16 v[220:223], a[220:223], v[124:127], v[220:223]
    s_waitcnt lgkmcnt(8)
    s_waitcnt vmcnt(11)
    v_mfma_f32_16x16x32_bf16 v[192:195], a[224:227], v[128:131], v[192:195]
    s_add_u32 s41, s38, 4096
    s_and_b32 s41, s41, 0x7fff
    s_or_b32 s38, s55, s41
    buffer_load_dwordx4 v[96:99], v20, s[28:31], s38 offen offset:0 sc1
    v_mfma_f32_16x16x32_bf16 v[196:199], a[228:231], v[128:131], v[196:199]
    v_mfma_f32_16x16x32_bf16 v[200:203], a[232:235], v[128:131], v[200:203]
    v_mfma_f32_16x16x32_bf16 v[204:207], a[236:239], v[128:131], v[204:207]
    s_waitcnt vmcnt(11)
    v_mfma_f32_16x16x32_bf16 v[208:211], a[224:227], v[132:135], v[208:211]
    buffer_load_dwordx4 v[100:103], v21, s[28:31], s38 offen offset:0 sc1
    v_mfma_f32_16x16x32_bf16 v[212:215], a[228:231], v[132:135], v[212:215]
    v_mfma_f32_16x16x32_bf16 v[216:219], a[232:235], v[132:135], v[216:219]
    v_mfma_f32_16x16x32_bf16 v[220:223], a[236:239], v[132:135], v[220:223]
    s_waitcnt lgkmcnt(0)
    s_waitcnt vmcnt(11)
    v_mfma_f32_16x16x32_bf16 v[192:195], a[240:243], v[136:139], v[192:195]
    buffer_load_dwordx4 v[104:107], v20, s[28:31], s38 offen offset:2048 sc1
    v_mfma_f32_16x16x32_bf16 v[196:199], a[244:247], v[136:139], v[196:199]
    v_mfma_f32_16x16x32_bf16 v[200:203], a[248:251], v[136:139], v[200:203]
    v_mfma_f32_16x16x32_bf16 v[204:207], a[252:255], v[136:139], v[204:207]
    s_waitcnt vmcnt(11)
    v_mfma_f32_16x16x32_bf16 v[208:211], a[240:243], v[140:143], v[208:211]
    buffer_load_dwordx4 v[108:111], v21, s[28:31], s38 offen offset:2048 sc1
    v_mfma_f32_16x16x32_bf16 v[212:215], a[244:247], v[140:143], v[212:215]
    v_mfma_f32_16x16x32_bf16 v[216:219], a[248:251], v[140:143], v[216:219]
    v_mfma_f32_16x16x32_bf16 v[220:223], a[252:255], v[140:143], v[220:223]
    s_waitcnt vmcnt(11)
    v_mfma_f32_16x16x32_bf16 v[224:227], a[0:3], v[144:147], 0
    s_add_u32 s41, s38, 4096
    s_and_b32 s41, s41, 0x7fff
    s_or_b32 s38, s55, s41
    buffer_load_dwordx4 v[112:115], v20, s[28:31], s38 offen offset:0 sc1
    v_mfma_f32_16x16x32_bf16 v[228:231], a[4:7], v[144:147], 0
    v_mfma_f32_16x16x32_bf16 v[232:235], a[8:11], v[144:147], 0
    v_mfma_f32_16x16x32_bf16 v[236:239], a[12:15], v[144:147], 0
    s_waitcnt vmcnt(11)
    v_mfma_f32_16x16x32_bf16 v[240:243], a[0:3], v[148:151], 0
    buffer_load_dwordx4 v[116:119], v21, s[28:31], s38 offen offset:0 sc1
    v_mfma_f32_16x16x32_bf16 v[244:247], a[4:7], v[148:151], 0
    v_mfma_f32_16x16x32_bf16 v[248:251], a[8:11], v[148:151], 0
    v_mfma_f32_16x16x32_bf16 v[252:255], a[12:15], v[148:151], 0
    s_waitcnt vmcnt(11)
    v_mfma_f32_16x16x32_bf16 v[224:227], a[16:19], v[152:155], v[224:227]
    buffer_load_dwordx4 v[120:123], v20, s[28:31], s38 offen offset:2048 sc1
    s_mov_b32 m0, s79
    s_nop 0
    ds_write_addtid_b32 v200 offset:0
    v_mfma_f32_16x16x32_bf16 v[228:231], a[20:23], v[152:155], v[228:231]
    ds_write_addtid_b32 v201 offset:256
    ds_write_addtid_b32 v202 offset:512
    v_mfma_f32_16x16x32_bf16 v[232:235], a[24:27], v[152:155], v[232:235]
    ds_write_addtid_b32 v203 offset:768
    ds_write_addtid_b32 v204 offset:1024
    v_mfma_f32_16x16x32_bf16 v[236:239], a[28:31], v[152:155], v[236:239]
    ds_write_addtid_b32 v205 offset:1280
    s_waitcnt vmcnt(11)
    v_mfma_f32_16x16x32_bf16 v[240:243], a[16:19], v[156:159], v[240:243]
    buffer_load_dwordx4 v[124:127], v21, s[28:31], s38 offen offset:2048 sc1
    ds_write_addtid_b32 v206 offset:1536
    v_mfma_f32_16x16x32_bf16 v[244:247], a[20:23], v[156:159], v[244:247]
    ds_write_addtid_b32 v207 offset:1792
    ds_write_addtid_b32 v208 offset:2048
    v_mfma_f32_16x16x32_bf16 v[248:251], a[24:27], v[156:159], v[248:251]
    ds_write_addtid_b32 v209 offset:2304
    ds_write_addtid_b32 v210 offset:2560
    v_mfma_f32_16x16x32_bf16 v[252:255], a[28:31], v[156:159], v[252:255]
    ds_write_addtid_b32 v211 offset:2816
    s_waitcnt vmcnt(11)
    v_mfma_f32_16x16x32_bf16 v[224:227], a[32:35], v[160:163], v[224:227]
    s_add_u32 s41, s38, 4096
    s_and_b32 s41, s41, 0x7fff
    s_or_b32 s38, s55, s41
    buffer_load_dwordx4 v[128:131], v20, s[28:31], s38 offen offset:0 sc1
    ds_write_addtid_b32 v212 offset:3072
    v_mfma_f32_16x16x32_bf16 v[228:231], a[36:39], v[160:163], v[228:231]
    ds_write_addtid_b32 v213 offset:3328
    ds_write_addtid_b32 v214 offset:3584
    v_mfma_f32_16x16x32_bf16 v[232:235], a[40:43], v[160:163], v[232:235]
    ds_write_addtid_b32 v215 offset:3840
    ds_write_addtid_b32 v216 offset:4096
    v_mfma_f32_16x16x32_bf16 v[236:239], a[44:47], v[160:163], v[236:239]
    ds_write_addtid_b32 v217 offset:4352
    s_waitcnt vmcnt(11)
    v_mfma_f32_16x16x32_bf16 v[240:243], a[32:35], v[164:167], v[240:243]
    buffer_load_dwordx4 v[132:135], v21, s[28:31], s38 offen offset:0 sc1
    ds_write_addtid_b32 v218 offset:4608
    v_mfma_f32_16x16x32_bf16 v[244:247], a[36:39], v[164:167], v[244:247]
    ds_write_addtid_b32 v219 offset:4864
    ds_write_addtid_b32 v220 offset:5120
    v_mfma_f32_16x16x32_bf16 v[248:251], a[40:43], v[164:167], v[248:251]
    ds_write_addtid_b32 v221 offset:5376
    ds_write_addtid_b32 v222 offset:5632
    v_mfma_f32_16x16x32_bf16 v[252:255], a[44:47], v[164:167], v[252:255]
    ds_write_addtid_b32 v223 offset:5888
    s_waitcnt vmcnt(11)
    v_mfma_f32_16x16x32_bf16 v[224:227], a[48:51], v[168:171], v[224:227]
    buffer_load_dwordx4 v[136:139], v20, s[28:31], s38 offen offset:2048 sc1
    v_mfma_f32_16x16x32_bf16 v[228:231], a[52:55], v[168:171], v[228:231]
    v_mfma_f32_16x16x32_bf16 v[232:235], a[56:59], v[168:171], v[232:235]
    v_mfma_f32_16x16x32_bf16 v[236:239], a[60:63], v[168:171], v[236:239]
    s_waitcnt lgkmcnt(0)
    s_barrier
    s_waitcnt vmcnt(11)
    v_mfma_f32_16x16x32_bf16 v[240:243], a[48:51], v[172:175], v[240:243]
    buffer_load_dwordx4 v[140:143], v21, s[28:31], s38 offen offset:2048 sc1
    ds_read2st64_b32 v[48:49], v186 offset0:0 offset1:1
    v_mfma_f32_16x16x32_bf16 v[244:247], a[52:55], v[172:175], v[244:247]
    ds_read2st64_b32 v[50:51], v186 offset0:2 offset1:3
    ds_read2st64_b32 v[52:53], v186 offset0:4 offset1:5
    v_mfma_f32_16x16x32_bf16 v[248:251], a[56:59], v[172:175], v[248:251]
    ds_read2st64_b32 v[54:55], v186 offset0:6 offset1:7
    ds_read2st64_b32 v[56:57], v187 offset0:8 offset1:9
    v_mfma_f32_16x16x32_bf16 v[252:255], a[60:63], v[172:175], v[252:255]
    ds_read2st64_b32 v[58:59], v187 offset0:10 offset1:11
    s_waitcnt vmcnt(11)
    v_mfma_f32_16x16x32_bf16 v[224:227], a[64:67], v[96:99], v[224:227]
    s_add_u32 s41, s38, 4096
    s_and_b32 s41, s41, 0x7fff
    s_or_b32 s38, s55, s41
    buffer_load_dwordx4 v[144:147], v20, s[28:31], s38 offen offset:0 sc1
    ds_read2st64_b32 v[60:61], v187 offset0:12 offset1:13
    v_mfma_f32_16x16x32_bf16 v[228:231], a[68:71], v[96:99], v[228:231]
    ds_read2st64_b32 v[62:63], v187 offset0:14 offset1:15
    ds_read2st64_b32 v[64:65], v188 offset0:16 offset1:17
    v_mfma_f32_16x16x32_bf16 v[232:235], a[72:75], v[96:99], v[232:235]
    ds_read2st64_b32 v[66:67], v188 offset0:18 offset1:19
    ds_read2st64_b32 v[68:69], v188 offset0:20 offset1:21
    v_mfma_f32_16x16x32_bf16 v[236:239], a[76:79], v[96:99], v[236:239]
    ds_read2st64_b32 v[70:71], v188 offset0:22 offset1:23
    s_waitcnt vmcnt(11)
    v_mfma_f32_16x16x32_bf16 v[240:243], a[64:67], v[100:103], v[240:243]
    buffer_load_dwordx4 v[148:151], v21, s[28:31], s38 offen offset:0 sc1
    v_mfma_f32_16x16x32_bf16 v[244:247], a[68:71], v[100:103], v[244:247]
    v_mfma_f32_16x16x32_bf16 v[248:251], a[72:75], v[100:103], v[248:251]
    v_mfma_f32_16x16x32_bf16 v[252:255], a[76:79], v[100:103], v[252:255]
    s_waitcnt vmcnt(11)
    v_mfma_f32_16x16x32_bf16 v[224:227], a[80:83], v[104:107], v[224:227]
    buffer_load_dwordx4 v[152:155], v20, s[28:31], s38 offen offset:2048 sc1
    v_mfma_f32_16x16x32_bf16 v[228:231], a[84:87], v[104:107], v[228:231]
    v_mfma_f32_16x16x32_bf16 v[232:235], a[88:91], v[104:107], v[232:235]
    v_mfma_f32_16x16x32_bf16 v[236:239], a[92:95], v[104:107], v[236:239]
    s_waitcnt lgkmcnt(8)
    v_add_f32 v48, v48, v192
    s_waitcnt vmcnt(11)
    v_mfma_f32_16x16x32_bf16 v[240:243], a[80:83], v[108:111], v[240:243]
    buffer_load_dwordx4 v[156:159], v21, s[28:31], s38 offen offset:2048 sc1
    v_add_f32 v49, v49, v193
    v_mfma_f32_16x16x32_bf16 v[244:247], a[84:87], v[108:111], v[244:247]
    v_add_f32 v50, v50, v194
    v_add_f32 v51, v51, v195
    v_mfma_f32_16x16x32_bf16 v[248:251], a[88:91], v[108:111], v[248:251]
    v_add_f32 v52, v52, v196
    v_add_f32 v53, v53, v197
    v_mfma_f32_16x16x32_bf16 v[252:255], a[92:95], v[108:111], v[252:255]
    v_add_f32 v54, v54, v198
    s_waitcnt vmcnt(11)
    v_mfma_f32_16x16x32_bf16 v[224:227], a[96:99], v[112:115], v[224:227]
    s_add_u32 s41, s38, 4096
    s_and_b32 s41, s41, 0x7fff
    s_or_b32 s38, s55, s41
    buffer_load_dwordx4 v[160:163], v20, s[28:31], s38 offen offset:0 sc1
    v_add_f32 v55, v55, v199
    v_mfma_f32_16x16x32_bf16 v[228:231], a[100:103], v[112:115], v[228:231]
    s_waitcnt lgkmcnt(0)
    v_add_f32 v56, v56, v64
    v_add_f32 v57, v57, v65
    v_mfma_f32_16x16x32_bf16 v[232:235], a[104:107], v[112:115], v[232:235]
    v_add_f32 v58, v58, v66
    v_add_f32 v59, v59, v67
    v_mfma_f32_16x16x32_bf16 v[236:239], a[108:111], v[112:115], v[236:239]
    v_add_f32 v60, v60, v68
    s_waitcnt vmcnt(11)
    v_mfma_f32_16x16x32_bf16 v[240:243], a[96:99], v[116:119], v[240:243]
    buffer_load_dwordx4 v[164:167], v21, s[28:31], s38 offen offset:0 sc1
    v_add_f32 v61, v61, v69
    v_mfma_f32_16x16x32_bf16 v[244:247], a[100:103], v[116:119], v[244:247]
    v_add_f32 v62, v62, v70
    v_add_f32 v63, v63, v71
    v_mfma_f32_16x16x32_bf16 v[248:251], a[104:107], v[116:119], v[248:251]
    v_add_f32 v72, v48, v56
    v_add_f32 v73, v49, v57
    v_mfma_f32_16x16x32_bf16 v[252:255], a[108:111], v[116:119], v[252:255]
    v_add_f32 v74, v50, v58
    s_waitcnt vmcnt(11)
    v_mfma_f32_16x16x32_bf16 v[224:227], a[112:115], v[120:123], v[224:227]
    buffer_load_dwordx4 v[168:171], v20, s[28:31], s38 offen offset:2048 sc1
    v_add_f32 v75, v51, v59
    v_mfma_f32_16x16x32_bf16 v[228:231], a[116:119], v[120:123], v[228:231]
    v_add_f32 v76, v52, v60
    v_add_f32 v77, v53, v61
    v_mfma_f32_16x16x32_bf16 v[232:235], a[120:123], v[120:123], v[232:235]
    v_add_f32 v78, v54, v62
    v_add_f32 v79, v55, v63
    v_mfma_f32_16x16x32_bf16 v[236:239], a[124:127], v[120:123], v[236:239]
    v_cvt_pk_bf16_f32 v72, 0, v72
    s_waitcnt vmcnt(11)
    v_mfma_f32_16x16x32_bf16 v[240:243], a[112:115], v[124:127], v[240:243]
    buffer_load_dwordx4 v[172:175], v21, s[28:31], s38 offen offset:2048 sc1
    v_cvt_pk_bf16_f32 v73, 0, v73
    v_mfma_f32_16x16x32_bf16 v[244:247], a[116:119], v[124:127], v[244:247]
    v_cvt_pk_bf16_f32 v74, 0, v74
    v_cvt_pk_bf16_f32 v75, 0, v75
    v_mfma_f32_16x16x32_bf16 v[248:251], a[120:123], v[124:127], v[248:251]
    v_cvt_pk_bf16_f32 v76, 0, v76
    v_cvt_pk_bf16_f32 v77, 0, v77
    v_mfma_f32_16x16x32_bf16 v[252:255], a[124:127], v[124:127], v[252:255]
    v_cvt_pk_bf16_f32 v78, 0, v78
    s_waitcnt vmcnt(11)
    v_mfma_f32_16x16x32_bf16 v[224:227], a[128:131], v[128:131], v[224:227]
    s_add_u32 s41, s38, 4096
    s_and_b32 s41, s41, 0x7fff
    s_or_b32 s38, s55, s41
    buffer_load_dwordx4 v[96:99], v20, s[28:31], s38 offen offset:0 sc1
    v_cvt_pk_bf16_f32 v79, 0, v79
    v_mfma_f32_16x16x32_bf16 v[228:231], a[132:135], v[128:131], v[228:231]
    v_add_f32 v72, v72, v40
    v_add_f32 v73, v73, v41
    v_mfma_f32_16x16x32_bf16 v[232:235], a[136:139], v[128:131], v[232:235]
    v_add_f32 v74, v74, v42
    v_add_f32 v75, v75, v43
    v_mfma_f32_16x16x32_bf16 v[236:239], a[140:143], v[128:131], v[236:239]
    v_add_f32 v76, v76, v44
    s_waitcnt vmcnt(11)
    v_mfma_f32_16x16x32_bf16 v[240:243], a[128:131], v[132:135], v[240:243]
    buffer_load_dwordx4 v[100:103], v21, s[28:31], s38 offen offset:0 sc1
    v_add_f32 v77, v77, v45
    v_mfma_f32_16x16x32_bf16 v[244:247], a[132:135], v[132:135], v[244:247]
    v_add_f32 v78, v78, v46
    v_add_f32 v79, v79, v47
    v_mfma_f32_16x16x32_bf16 v[248:251], a[136:139], v[132:135], v[248:251]
    v_cvt_pk_bf16_f32 v72, 0, v72
    v_cvt_pk_bf16_f32 v73, 0, v73
    v_mfma_f32_16x16x32_bf16 v[252:255], a[140:143], v[132:135], v[252:255]
    v_cvt_pk_bf16_f32 v74, 0, v74
    s_waitcnt vmcnt(11)
    v_mfma_f32_16x16x32_bf16 v[224:227], a[144:147], v[136:139], v[224:227]
    buffer_load_dwordx4 v[104:107], v20, s[28:31], s38 offen offset:2048 sc1
    v_cvt_pk_bf16_f32 v75, 0, v75
    v_mfma_f32_16x16x32_bf16 v[228:231], a[148:151], v[136:139], v[228:231]
    v_cvt_pk_bf16_f32 v76, 0, v76
    v_cvt_pk_bf16_f32 v77, 0, v77
    v_mfma_f32_16x16x32_bf16 v[232:235], a[152:155], v[136:139], v[232:235]
    v_cvt_pk_bf16_f32 v78, 0, v78
    v_cvt_pk_bf16_f32 v79, 0, v79
    v_mfma_f32_16x16x32_bf16 v[236:239], a[156:159], v[136:139], v[236:239]
    v_mul_f32 v80, v72, v72
    s_waitcnt vmcnt(11)
    v_mfma_f32_16x16x32_bf16 v[240:243], a[144:147], v[140:143], v[240:243]
    buffer_load_dwordx4 v[108:111], v21, s[28:31], s38 offen offset:2048 sc1
    v_mul_f32 v81, v73, v73
    v_mfma_f32_16x16x32_bf16 v[244:247], a[148:151], v[140:143], v[244:247]
    v_mul_f32 v82, v74, v74
    v_mul_f32 v83, v75, v75
    v_mfma_f32_16x16x32_bf16 v[248:251], a[152:155], v[140:143], v[248:251]
    v_mul_f32 v84, v76, v76
    v_mul_f32 v85, v77, v77
    v_mfma_f32_16x16x32_bf16 v[252:255], a[156:159], v[140:143], v[252:255]
    v_mul_f32 v86, v78, v78
    s_waitcnt vmcnt(11)
    v_mfma_f32_16x16x32_bf16 v[224:227], a[160:163], v[144:147], v[224:227]
    s_add_u32 m0, s36, 8192
    s_add_u32 s68, s68, 131072
    buffer_load_dwordx4 v7, s[24:27], s68 offen offset:0 lds
    v_mul_f32 v87, v79, v79
    v_mfma_f32_16x16x32_bf16 v[228:231], a[164:167], v[144:147], v[228:231]
    v_fma_f32 v80, v80, v176, v178
    v_fma_f32 v81, v81, v176, v178
    v_mfma_f32_16x16x32_bf16 v[232:235], a[168:171], v[144:147], v[232:235]
    v_fma_f32 v82, v82, v176, v178
    v_fma_f32 v83, v83, v176, v178
    v_mfma_f32_16x16x32_bf16 v[236:239], a[172:175], v[144:147], v[236:239]
    v_fma_f32 v84, v84, v176, v178
    s_waitcnt vmcnt(11)
    v_mfma_f32_16x16x32_bf16 v[240:243], a[160:163], v[148:151], v[240:243]
    buffer_load_dwordx4 v8, s[24:27], s68 offen offset:1024 lds
    v_fma_f32 v85, v85, v176, v178
    v_mfma_f32_16x16x32_bf16 v[244:247], a[164:167], v[148:151], v[244:247]
    v_fma_f32 v86, v86, v176, v178
    v_fma_f32 v87, v87, v176, v178
    v_mfma_f32_16x16x32_bf16 v[248:251], a[168:171], v[148:151], v[248:251]
    v_mul_f32 v80, v80, v72
    v_mul_f32 v81, v81, v73
    v_mfma_f32_16x16x32_bf16 v[252:255], a[172:175], v[148:151], v[252:255]
    v_mul_f32 v82, v82, v74
    s_waitcnt vmcnt(11)
    v_mfma_f32_16x16x32_bf16 v[224:227], a[176:179], v[152:155], v[224:227]
    buffer_load_dwordx4 v9, s[24:27], s68 offen offset:2048 lds
    v_mul_f32 v83, v83, v75
    v_mfma_f32_16x16x32_bf16 v[228:231], a[180:183], v[152:155], v[228:231]
    v_mul_f32 v84, v84, v76
    v_mul_f32 v85, v85, v77
    v_mfma_f32_16x16x32_bf16 v[232:235], a[184:187], v[152:155], v[232:235]
    v_mul_f32 v86, v86, v78
    v_mul_f32 v87, v87, v79
    v_mfma_f32_16x16x32_bf16 v[236:239], a[188:191], v[152:155], v[236:239]
    v_exp_f32 v80, v80
    s_waitcnt vmcnt(11)
    v_mfma_f32_16x16x32_bf16 v[240:243], a[176:179], v[156:159], v[240:243]
    buffer_load_dwordx4 v10, s[24:27], s68 offen offset:3072 lds
    v_exp_f32 v81, v81
    v_mfma_f32_16x16x32_bf16 v[244:247], a[180:183], v[156:159], v[244:247]
    v_exp_f32 v82, v82
    v_exp_f32 v83, v83
    v_mfma_f32_16x16x32_bf16 v[248:251], a[184:187], v[156:159], v[248:251]
    v_exp_f32 v84, v84
    v_exp_f32 v85, v85
    v_mfma_f32_16x16x32_bf16 v[252:255], a[188:191], v[156:159], v[252:255]
    v_exp_f32 v86, v86
    s_waitcnt vmcnt(11)
    v_mfma_f32_16x16x32_bf16 v[224:227], a[192:195], v[160:163], v[224:227]
    s_add_u32 m0, s36, 12288
    s_add_u32 s68, s68, 131072
    buffer_load_dwordx4 v7, s[24:27], s68 offen offset:0 lds
    v_exp_f32 v87, v87
    v_mfma_f32_16x16x32_bf16 v[228:231], a[196:199], v[160:163], v[228:231]
    v_add_f32 v80, 1.0, v80
    v_add_f32 v81, 1.0, v81
    v_mfma_f32_16x16x32_bf16 v[232:235], a[200:203], v[160:163], v[232:235]
    v_add_f32 v82, 1.0, v82
    v_add_f32 v83, 1.0, v83
    v_mfma_f32_16x16x32_bf16 v[236:239], a[204:207], v[160:163], v[236:239]
    v_add_f32 v84, 1.0, v84
    s_waitcnt vmcnt(11)
    v_mfma_f32_16x16x32_bf16 v[240:243], a[192:195], v[164:167], v[240:243]
    buffer_load_dwordx4 v8, s[24:27], s68 offen offset:1024 lds
    v_add_f32 v85, 1.0, v85
    v_mfma_f32_16x16x32_bf16 v[244:247], a[196:199], v[164:167], v[244:247]
    v_add_f32 v86, 1.0, v86
    v_add_f32 v87, 1.0, v87
    v_mfma_f32_16x16x32_bf16 v[248:251], a[200:203], v[164:167], v[248:251]
    v_rcp_f32 v80, v80
    v_rcp_f32 v81, v81
    v_mfma_f32_16x16x32_bf16 v[252:255], a[204:207], v[164:167], v[252:255]
    v_rcp_f32 v82, v82
    s_waitcnt vmcnt(11)
    v_mfma_f32_16x16x32_bf16 v[224:227], a[208:211], v[168:171], v[224:227]
    buffer_load_dwordx4 v9, s[24:27], s68 offen offset:2048 lds
    v_rcp_f32 v83, v83
    v_mfma_f32_16x16x32_bf16 v[228:231], a[212:215], v[168:171], v[228:231]
    v_rcp_f32 v84, v84
    v_rcp_f32 v85, v85
    v_mfma_f32_16x16x32_bf16 v[232:235], a[216:219], v[168:171], v[232:235]
    v_rcp_f32 v86, v86
    v_rcp_f32 v87, v87
    v_mfma_f32_16x16x32_bf16 v[236:239], a[220:223], v[168:171], v[236:239]
    v_mul_f32 v72, v72, v80
    s_waitcnt vmcnt(11)
    v_mfma_f32_16x16x32_bf16 v[240:243], a[208:211], v[172:175], v[240:243]
    buffer_load_dwordx4 v10, s[24:27], s68 offen offset:3072 lds
    v_mul_f32 v73, v73, v81
    v_mfma_f32_16x16x32_bf16 v[244:247], a[212:215], v[172:175], v[244:247]
    v_mul_f32 v74, v74, v82
    v_mul_f32 v75, v75, v83
    v_mfma_f32_16x16x32_bf16 v[248:251], a[216:219], v[172:175], v[248:251]
    v_mul_f32 v76, v76, v84
    v_mul_f32 v77, v77, v85
    v_mfma_f32_16x16x32_bf16 v[252:255], a[220:223], v[172:175], v[252:255]
    v_mul_f32 v78, v78, v86
    s_waitcnt vmcnt(11)
    v_mfma_f32_16x16x32_bf16 v[224:227], a[224:227], v[96:99], v[224:227]
    s_add_u32 m0, s36, 16384
    s_add_u32 s68, s68, 131072
    buffer_load_dwordx4 v7, s[24:27], s68 offen offset:0 lds
    v_mul_f32 v79, v79, v87
    v_mfma_f32_16x16x32_bf16 v[228:231], a[228:231], v[96:99], v[228:231]
    v_cvt_pk_bf16_f32 v88, v72, v73
    v_cvt_pk_bf16_f32 v89, v74, v75
    v_mfma_f32_16x16x32_bf16 v[232:235], a[232:235], v[96:99], v[232:235]
    v_cvt_pk_bf16_f32 v90, v76, v77
    v_cvt_pk_bf16_f32 v91, v78, v79
    v_mfma_f32_16x16x32_bf16 v[236:239], a[236:239], v[96:99], v[236:239]
    buffer_store_dwordx4 v[88:91], v31, s[28:31], s56 offen sc1
    s_waitcnt vmcnt(12)
    v_mfma_f32_16x16x32_bf16 v[240:243], a[224:227], v[100:103], v[240:243]
    buffer_load_dwordx4 v8, s[24:27], s68 offen offset:1024 lds
    v_mfma_f32_16x16x32_bf16 v[244:247], a[228:231], v[100:103], v[244:247]
    v_mfma_f32_16x16x32_bf16 v[248:251], a[232:235], v[100:103], v[248:251]
    v_mfma_f32_16x16x32_bf16 v[252:255], a[236:239], v[100:103], v[252:255]
    s_waitcnt vmcnt(12)
    v_mfma_f32_16x16x32_bf16 v[224:227], a[240:243], v[104:107], v[224:227]
    buffer_load_dwordx4 v9, s[24:27], s68 offen offset:2048 lds
    v_mfma_f32_16x16x32_bf16 v[228:231], a[244:247], v[104:107], v[228:231]
    v_mfma_f32_16x16x32_bf16 v[232:235], a[248:251], v[104:107], v[232:235]
    v_mfma_f32_16x16x32_bf16 v[236:239], a[252:255], v[104:107], v[236:239]
    s_waitcnt vmcnt(12)
    v_mfma_f32_16x16x32_bf16 v[240:243], a[240:243], v[108:111], v[240:243]
    buffer_load_dwordx4 v10, s[24:27], s68 offen offset:3072 lds
    v_mfma_f32_16x16x32_bf16 v[244:247], a[244:247], v[108:111], v[244:247]
    v_mfma_f32_16x16x32_bf16 v[248:251], a[248:251], v[108:111], v[248:251]
    v_mfma_f32_16x16x32_bf16 v[252:255], a[252:255], v[108:111], v[252:255]
    s_nop 7
    s_mov_b32 m0, s79
    s_nop 0
    ds_write_addtid_b32 v232 offset:24576
    ds_write_addtid_b32 v233 offset:24832
    ds_write_addtid_b32 v234 offset:25088
    ds_write_addtid_b32 v235 offset:25344
    ds_write_addtid_b32 v236 offset:25600
    ds_write_addtid_b32 v237 offset:25856
    ds_write_addtid_b32 v238 offset:26112
    ds_write_addtid_b32 v239 offset:26368
    ds_write_addtid_b32 v240 offset:26624
    ds_write_addtid_b32 v241 offset:26880
    ds_write_addtid_b32 v242 offset:27136
    ds_write_addtid_b32 v243 offset:27392
    ds_write_addtid_b32 v244 offset:27648
    ds_write_addtid_b32 v245 offset:27904
    ds_write_addtid_b32 v246 offset:28160
    ds_write_addtid_b32 v247 offset:28416
    ds_write_addtid_b32 v248 offset:28672
    ds_write_addtid_b32 v249 offset:28928
    ds_write_addtid_b32 v250 offset:29184
    ds_write_addtid_b32 v251 offset:29440
    ds_write_addtid_b32 v252 offset:29696
    ds_write_addtid_b32 v253 offset:29952
    ds_write_addtid_b32 v254 offset:30208
    ds_write_addtid_b32 v255 offset:30464
    s_add_u32 m0, s36, 20480
    s_add_u32 s68, s68, 131072
    buffer_load_dwordx4 v7, s[24:27], s68 offen offset:0 lds
    buffer_load_dwordx4 v8, s[24:27], s68 offen offset:1024 lds
    buffer_load_dwordx4 v9, s[24:27], s68 offen offset:2048 lds
    s_waitcnt vmcnt(12)
    ds_read_b64_tr_b16 a[0:1], v15 offset:8192
    ds_read_b64_tr_b16 a[2:3], v15 offset:10240
    ds_read_b64_tr_b16 a[4:5], v16 offset:8192
    s_waitcnt lgkmcnt(3)
    s_barrier
    ds_read2st64_b32 v[48:49], v186 offset0:96 offset1:97
    ds_read2st64_b32 v[50:51], v186 offset0:98 offset1:99
    ds_read2st64_b32 v[52:53], v186 offset0:100 offset1:101
    ds_read2st64_b32 v[54:55], v186 offset0:102 offset1:103
    ds_read2st64_b32 v[56:57], v187 offset0:104 offset1:105
    ds_read2st64_b32 v[58:59], v187 offset0:106 offset1:107
    ds_read2st64_b32 v[60:61], v187 offset0:108 offset1:109
    ds_read2st64_b32 v[62:63], v187 offset0:110 offset1:111
    ds_read2st64_b32 v[64:65], v188 offset0:112 offset1:113
    buffer_load_dwordx4 v10, s[24:27], s68 offen offset:3072 lds
    ds_read_b64_tr_b16 a[6:7], v16 offset:10240
    ds_read_b64_tr_b16 a[8:9], v17 offset:8192
    ds_read_b64_tr_b16 a[10:11], v17 offset:10240
    ds_read2st64_b32 v[66:67], v188 offset0:114 offset1:115
    ds_read2st64_b32 v[68:69], v188 offset0:116 offset1:117
    ds_read2st64_b32 v[70:71], v188 offset0:118 offset1:119
    s_add_u32 m0, s36, 24576
    s_add_u32 s68, s68, 131072
    buffer_load_dwordx4 v7, s[24:27], s68 offen offset:0 lds
    ds_read_b64_tr_b16 a[12:13], v18 offset:8192
    ds_read_b64_tr_b16 a[14:15], v18 offset:10240
    buffer_load_dwordx4 v8, s[24:27], s68 offen offset:1024 lds
    buffer_load_dwordx4 v9, s[24:27], s68 offen offset:2048 lds
    s_waitcnt vmcnt(12)
    ds_read_b64_tr_b16 a[16:17], v15 offset:12288
    ds_read_b64_tr_b16 a[18:19], v15 offset:14336
    ds_read_b64_tr_b16 a[20:21], v16 offset:12288
    s_waitcnt lgkmcnt(15)
    v_pk_add_f32 v[48:49], v[48:49], v[224:225]
    v_pk_add_f32 v[50:51], v[50:51], v[226:227]
    v_pk_add_f32 v[52:53], v[52:53], v[228:229]
    v_pk_add_f32 v[54:55], v[54:55], v[230:231]
    s_waitcnt lgkmcnt(5)
    v_pk_add_f32 v[56:57], v[56:57], v[64:65]
    v_pk_add_f32 v[58:59], v[58:59], v[66:67]
    v_pk_add_f32 v[60:61], v[60:61], v[68:69]
    v_pk_add_f32 v[62:63], v[62:63], v[70:71]
    v_pk_add_f32 v[72:73], v[48:49], v[56:57]
    v_pk_add_f32 v[74:75], v[50:51], v[58:59]
    buffer_load_dwordx4 v10, s[24:27], s68 offen offset:3072 lds
    ds_read_b64_tr_b16 a[22:23], v16 offset:14336
    ds_read_b64_tr_b16 a[24:25], v17 offset:12288
    ds_read_b64_tr_b16 a[26:27], v17 offset:14336
    v_pk_add_f32 v[76:77], v[52:53], v[60:61]
    v_pk_add_f32 v[78:79], v[54:55], v[62:63]
    v_cvt_pk_bf16_f32 v72, 0, v72
    v_cvt_pk_bf16_f32 v73, 0, v73
    v_cvt_pk_bf16_f32 v74, 0, v74
    v_cvt_pk_bf16_f32 v75, 0, v75
    v_cvt_pk_bf16_f32 v76, 0, v76
    v_cvt_pk_bf16_f32 v77, 0, v77
    v_cvt_pk_bf16_f32 v78, 0, v78
    v_cvt_pk_bf16_f32 v79, 0, v79
    s_add_u32 m0, s36, 0
    s_add_u32 s68, s68, 131072
    buffer_load_dwordx4 v7, s[24:27], s68 offen offset:0 lds
    s_waitcnt vmcnt(12)
    s_atomic_add s67, s[18:19], s64
    ds_read_b64_tr_b16 a[28:29], v18 offset:12288
    ds_read_b64_tr_b16 a[30:31], v18 offset:14336
    v_pk_add_f32 v[72:73], v[72:73], v[40:41]
    v_pk_add_f32 v[74:75], v[74:75], v[42:43]
    v_pk_add_f32 v[76:77], v[76:77], v[44:45]
    v_pk_add_f32 v[78:79], v[78:79], v[46:47]
    v_cvt_pk_bf16_f32 v72, 0, v72
    v_cvt_pk_bf16_f32 v73, 0, v73
    v_cvt_pk_bf16_f32 v74, 0, v74
    v_cvt_pk_bf16_f32 v75, 0, v75
    v_cvt_pk_bf16_f32 v76, 0, v76
    v_cvt_pk_bf16_f32 v77, 0, v77
    buffer_load_dwordx4 v8, s[24:27], s68 offen offset:1024 lds
    v_cvt_pk_bf16_f32 v78, 0, v78
    v_cvt_pk_bf16_f32 v79, 0, v79
    v_pk_mul_f32 v[80:81], v[72:73], v[72:73]
    v_pk_mul_f32 v[82:83], v[74:75], v[74:75]
    v_pk_mul_f32 v[84:85], v[76:77], v[76:77]
    v_pk_mul_f32 v[86:87], v[78:79], v[78:79]
    v_pk_fma_f32 v[80:81], v[80:81], v[176:177], v[178:179]
    v_pk_fma_f32 v[82:83], v[82:83], v[176:177], v[178:179]
    v_pk_fma_f32 v[84:85], v[84:85], v[176:177], v[178:179]
    v_pk_fma_f32 v[86:87], v[86:87], v[176:177], v[178:179]
    buffer_load_dwordx4 v9, s[24:27], s68 offen offset:2048 lds
    v_pk_mul_f32 v[80:81], v[80:81], v[72:73]
    v_pk_mul_f32 v[82:83], v[82:83], v[74:75]
    v_pk_mul_f32 v[84:85], v[84:85], v[76:77]
    v_pk_mul_f32 v[86:87], v[86:87], v[78:79]
    v_exp_f32 v80, v80
    v_exp_f32 v81, v81
    v_exp_f32 v82, v82
    v_exp_f32 v83, v83
    v_exp_f32 v84, v84
    v_exp_f32 v85, v85
    buffer_load_dwordx4 v10, s[24:27], s68 offen offset:3072 lds
    s_waitcnt vmcnt(12)
    ds_read_b64_tr_b16 a[32:33], v15 offset:16384
    ds_read_b64_tr_b16 a[34:35], v15 offset:18432
    ds_read_b64_tr_b16 a[36:37], v16 offset:16384
    v_exp_f32 v86, v86
    v_exp_f32 v87, v87
    v_pk_add_f32 v[80:81], v[80:81], v[180:181]
    v_pk_add_f32 v[82:83], v[82:83], v[180:181]
    v_pk_add_f32 v[84:85], v[84:85], v[180:181]
    v_pk_add_f32 v[86:87], v[86:87], v[180:181]
    v_rcp_f32 v80, v80
    v_rcp_f32 v81, v81
    v_rcp_f32 v82, v82
    v_rcp_f32 v83, v83
    s_add_u32 m0, s36, 4096
    s_add_u32 s68, s68, 131072
    buffer_load_dwordx4 v7, s[24:27], s68 offen offset:0 lds
    ds_read_b64_tr_b16 a[38:39], v16 offset:18432
    ds_read_b64_tr_b16 a[40:41], v17 offset:16384
    ds_read_b64_tr_b16 a[42:43], v17 offset:18432
    v_rcp_f32 v84, v84
    v_rcp_f32 v85, v85
    v_rcp_f32 v86, v86
    v_rcp_f32 v87, v87
    v_pk_mul_f32 v[72:73], v[72:73], v[80:81]
    v_pk_mul_f32 v[74:75], v[74:75], v[82:83]
    v_pk_mul_f32 v[76:77], v[76:77], v[84:85]
    v_pk_mul_f32 v[78:79], v[78:79], v[86:87]
    v_cvt_pk_bf16_f32 v92, v72, v73
    v_cvt_pk_bf16_f32 v93, v74, v75
    buffer_load_dwordx4 v8, s[24:27], s68 offen offset:1024 lds
    ds_read_b64_tr_b16 a[44:45], v18 offset:16384
    ds_read_b64_tr_b16 a[46:47], v18 offset:18432
    v_cvt_pk_bf16_f32 v94, v76, v77
    v_cvt_pk_bf16_f32 v95, v78, v79
    s_add_u32 s56, s56, 114688
    buffer_store_dwordx4 v[92:95], v31, s[28:31], s56 offen sc1
    buffer_load_dwordx4 v9, s[24:27], s68 offen offset:2048 lds
    s_waitcnt vmcnt(12)
    ds_read_b64_tr_b16 a[48:49], v15 offset:20480
    ds_read_b64_tr_b16 a[50:51], v15 offset:22528
    ds_read_b64_tr_b16 a[52:53], v16 offset:20480
    buffer_load_dwordx4 v10, s[24:27], s68 offen offset:3072 lds
    ds_read_b64_tr_b16 a[54:55], v16 offset:22528
    ds_read_b64_tr_b16 a[56:57], v17 offset:20480
    ds_read_b64_tr_b16 a[58:59], v17 offset:22528
    s_waitcnt lgkmcnt(15)
    s_add_u32 m0, s36, 8192
    s_add_u32 s68, s68, 131072
    buffer_load_dwordx4 v7, s[24:27], s68 offen offset:0 lds
    ds_read_b64_tr_b16 a[60:61], v18 offset:20480
    ds_read_b64_tr_b16 a[62:63], v18 offset:22528
    buffer_load_dwordx4 v8, s[24:27], s68 offen offset:1024 lds
    buffer_load_dwordx4 v9, s[24:27], s68 offen offset:2048 lds
    s_waitcnt vmcnt(12)
    ds_read_b64_tr_b16 a[64:65], v15 offset:24576
    ds_read_b64_tr_b16 a[66:67], v15 offset:26624
    ds_read_b64_tr_b16 a[68:69], v16 offset:24576
    buffer_load_dwordx4 v10, s[24:27], s68 offen offset:3072 lds
    ds_read_b64_tr_b16 a[70:71], v16 offset:26624
    ds_read_b64_tr_b16 a[72:73], v17 offset:24576
    ds_read_b64_tr_b16 a[74:75], v17 offset:26624
    s_waitcnt lgkmcnt(15)
    s_add_u32 m0, s36, 12288
    s_add_u32 s68, s68, 131072
    buffer_load_dwordx4 v7, s[24:27], s68 offen offset:0 lds
    ds_read_b64_tr_b16 a[76:77], v18 offset:24576
    ds_read_b64_tr_b16 a[78:79], v18 offset:26624
    buffer_load_dwordx4 v8, s[24:27], s68 offen offset:1024 lds
    buffer_load_dwordx4 v9, s[24:27], s68 offen offset:2048 lds
    s_waitcnt vmcnt(12)
    ds_read_b64_tr_b16 a[80:81], v15 offset:0
    ds_read_b64_tr_b16 a[82:83], v15 offset:2048
    ds_read_b64_tr_b16 a[84:85], v16 offset:0
    buffer_load_dwordx4 v10, s[24:27], s68 offen offset:3072 lds
    ds_read_b64_tr_b16 a[86:87], v16 offset:2048
    ds_read_b64_tr_b16 a[88:89], v17 offset:0
    ds_read_b64_tr_b16 a[90:91], v17 offset:2048
    s_waitcnt lgkmcnt(15)
    s_add_u32 m0, s36, 16384
    s_add_u32 s68, s68, 131072
    buffer_load_dwordx4 v7, s[24:27], s68 offen offset:0 lds
    ds_read_b64_tr_b16 a[92:93], v18 offset:0
    ds_read_b64_tr_b16 a[94:95], v18 offset:2048
    buffer_load_dwordx4 v8, s[24:27], s68 offen offset:1024 lds
    s_waitcnt vmcnt(12)
    s_add_u32 s64, s64, 512
    s_atomic_add s67, s[18:19], s64
    buffer_load_dwordx4 v9, s[24:27], s68 offen offset:2048 lds
    buffer_load_dwordx4 v10, s[24:27], s68 offen offset:3072 lds
    s_waitcnt vmcnt(12)
    ds_read_b64_tr_b16 a[96:97], v15 offset:4096
    ds_read_b64_tr_b16 a[98:99], v15 offset:6144
    ds_read_b64_tr_b16 a[100:101], v16 offset:4096
    s_waitcnt lgkmcnt(15)
    s_add_u32 m0, s36, 20480
    s_add_u32 s68, s68, 131072
    buffer_load_dwordx4 v7, s[24:27], s68 offen offset:0 lds
    ds_read_b64_tr_b16 a[102:103], v16 offset:6144
    ds_read_b64_tr_b16 a[104:105], v17 offset:4096
    ds_read_b64_tr_b16 a[106:107], v17 offset:6144
    buffer_load_dwordx4 v8, s[24:27], s68 offen offset:1024 lds
    ds_read_b64_tr_b16 a[108:109], v18 offset:4096
    ds_read_b64_tr_b16 a[110:111], v18 offset:6144
    s_mov_b32 s69, 0
    s_atomic_add s69, s[18:19], s65 glc
    buffer_load_dwordx4 v9, s[24:27], s68 offen offset:2048 lds
    buffer_load_dwordx4 v10, s[24:27], s68 offen offset:3072 lds
    s_waitcnt vmcnt(12)
    ds_read_b64_tr_b16 a[112:113], v15 offset:8192
    ds_read_b64_tr_b16 a[114:115], v15 offset:10240
    ds_read_b64_tr_b16 a[116:117], v16 offset:8192
    s_waitcnt lgkmcnt(15)
    s_add_u32 m0, s36, 24576
    s_add_u32 s68, s68, 131072
    buffer_load_dwordx4 v7, s[24:27], s68 offen offset:0 lds
    ds_read_b64_tr_b16 a[118:119], v16 offset:10240
    ds_read_b64_tr_b16 a[120:121], v17 offset:8192
    ds_read_b64_tr_b16 a[122:123], v17 offset:10240
    buffer_load_dwordx4 v8, s[24:27], s68 offen offset:1024 lds
    ds_read_b64_tr_b16 a[124:125], v18 offset:8192
    ds_read_b64_tr_b16 a[126:127], v18 offset:10240
    buffer_load_dwordx4 v9, s[24:27], s68 offen offset:2048 lds
    buffer_load_dwordx4 v10, s[24:27], s68 offen offset:3072 lds
    s_waitcnt vmcnt(12)
    ds_read_b64_tr_b16 a[128:129], v15 offset:12288
    ds_read_b64_tr_b16 a[130:131], v15 offset:14336
    ds_read_b64_tr_b16 a[132:133], v16 offset:12288
    s_waitcnt lgkmcnt(15)
    s_add_u32 m0, s36, 0
    s_add_u32 s68, s68, 131072
    buffer_load_dwordx4 v7, s[24:27], s68 offen offset:0 lds
    ds_read_b64_tr_b16 a[134:135], v16 offset:14336
    ds_read_b64_tr_b16 a[136:137], v17 offset:12288
    ds_read_b64_tr_b16 a[138:139], v17 offset:14336
    buffer_load_dwordx4 v8, s[24:27], s68 offen offset:1024 lds
    ds_read_b64_tr_b16 a[140:141], v18 offset:12288
    ds_read_b64_tr_b16 a[142:143], v18 offset:14336
    buffer_load_dwordx4 v9, s[24:27], s68 offen offset:2048 lds
    buffer_load_dwordx4 v10, s[24:27], s68 offen offset:3072 lds
    s_waitcnt vmcnt(12)
    ds_read_b64_tr_b16 a[144:145], v15 offset:16384
    ds_read_b64_tr_b16 a[146:147], v15 offset:18432
    ds_read_b64_tr_b16 a[148:149], v16 offset:16384
    s_waitcnt lgkmcnt(15)
    s_add_u32 m0, s36, 4096
    s_add_u32 s68, s68, 131072
    buffer_load_dwordx4 v7, s[24:27], s68 offen offset:0 lds
    ds_read_b64_tr_b16 a[150:151], v16 offset:18432
    ds_read_b64_tr_b16 a[152:153], v17 offset:16384
    ds_read_b64_tr_b16 a[154:155], v17 offset:18432
    buffer_load_dwordx4 v8, s[24:27], s68 offen offset:1024 lds
    ds_read_b64_tr_b16 a[156:157], v18 offset:16384
    ds_read_b64_tr_b16 a[158:159], v18 offset:18432
    buffer_load_dwordx4 v9, s[24:27], s68 offen offset:2048 lds
    buffer_load_dwordx4 v10, s[24:27], s68 offen offset:3072 lds
    s_waitcnt vmcnt(12)
    ds_read_b64_tr_b16 a[160:161], v15 offset:20480
    ds_read_b64_tr_b16 a[162:163], v15 offset:22528
    ds_read_b64_tr_b16 a[164:165], v16 offset:20480
    s_waitcnt lgkmcnt(0)
    s_cmp_eq_u32 s69, s70
    s_cbranch_scc1 L_poll2a_ok
    s_mov_b32 s40, 0x20000
L_poll2a:
    s_sleep 3
    s_mov_b32 s69, 0
    s_atomic_add s69, s[18:19], s65 glc
    s_waitcnt lgkmcnt(0)
    s_cmp_eq_u32 s69, s70
    s_cbranch_scc1 L_poll2a_ok
    s_sub_u32 s40, s40, 1
    s_cbranch_scc0 L_poll2a
L_poll2a_ok:
L_join2:
    s_mov_b32 s38, s57
    buffer_load_dwordx4 v[96:99], v31, s[28:31], s38 offen offset:0 sc1
    ds_read_b64_tr_b16 a[166:167], v16 offset:22528
    ds_read_b64_tr_b16 a[168:169], v17 offset:20480
    buffer_load_dwordx4 v[100:103], v31, s[28:31], s38 offen offset:1024 sc1
    ds_read_b64_tr_b16 a[170:171], v17 offset:22528
    ds_read_b64_tr_b16 a[172:173], v18 offset:20480
    buffer_load_dwordx4 v[104:107], v31, s[28:31], s38 offen offset:2048 sc1
    ds_read_b64_tr_b16 a[174:175], v18 offset:22528
    buffer_load_dwordx4 v[108:111], v31, s[28:31], s38 offen offset:3072 sc1
    s_waitcnt vmcnt(12)
    ds_read_b64_tr_b16 a[176:177], v15 offset:24576
    ds_read_b64_tr_b16 a[178:179], v15 offset:26624
    s_add_u32 s38, s57, 4096
    buffer_load_dwordx4 v[112:115], v31, s[28:31], s38 offen offset:0 sc1
    ds_read_b64_tr_b16 a[180:181], v16 offset:24576
    ds_read_b64_tr_b16 a[182:183], v16 offset:26624
    buffer_load_dwordx4 v[116:119], v31, s[28:31], s38 offen offset:1024 sc1
    ds_read_b64_tr_b16 a[184:185], v17 offset:24576
    ds_read_b64_tr_b16 a[186:187], v17 offset:26624
    buffer_load_dwordx4 v[120:123], v31, s[28:31], s38 offen offset:2048 sc1
    ds_read_b64_tr_b16 a[188:189], v18 offset:24576
    ds_read_b64_tr_b16 a[190:191], v18 offset:26624
    buffer_load_dwordx4 v[124:127], v31, s[28:31], s38 offen offset:3072 sc1
    s_waitcnt vmcnt(12)
    ds_read_b64_tr_b16 a[192:193], v15 offset:0
    ds_read_b64_tr_b16 a[194:195], v15 offset:2048
    s_add_u32 s38, s57, 8192
    buffer_load_dwordx4 v[128:131], v31, s[28:31], s38 offen offset:0 sc1
    ds_read_b64_tr_b16 a[196:197], v16 offset:0
    ds_read_b64_tr_b16 a[198:199], v16 offset:2048
    buffer_load_dwordx4 v[132:135], v31, s[28:31], s38 offen offset:1024 sc1
    ds_read_b64_tr_b16 a[200:201], v17 offset:0
    ds_read_b64_tr_b16 a[202:203], v17 offset:2048
    s_waitcnt vmcnt(9)
    v_mfma_f32_16x16x32_bf16 v[192:195], v[96:99], a[0:3], 0
    buffer_load_dwordx4 v[136:139], v31, s[28:31], s38 offen offset:2048 sc1
    ds_read_b64_tr_b16 a[204:205], v18 offset:0
    v_mfma_f32_16x16x32_bf16 v[200:203], v[96:99], a[4:7], 0
    ds_read_b64_tr_b16 a[206:207], v18 offset:2048
    v_mfma_f32_16x16x32_bf16 v[208:211], v[96:99], a[8:11], 0
    ds_read_b64_tr_b16 a[208:209], v15 offset:4096
    v_mfma_f32_16x16x32_bf16 v[216:219], v[96:99], a[12:15], 0
    ds_read_b64_tr_b16 a[210:211], v15 offset:6144
    s_waitcnt vmcnt(9)
    v_mfma_f32_16x16x32_bf16 v[196:199], v[100:103], a[0:3], 0
    buffer_load_dwordx4 v[140:143], v31, s[28:31], s38 offen offset:3072 sc1
    ds_read_b64_tr_b16 a[212:213], v16 offset:4096
    v_mfma_f32_16x16x32_bf16 v[204:207], v[100:103], a[4:7], 0
    ds_read_b64_tr_b16 a[214:215], v16 offset:6144
    v_mfma_f32_16x16x32_bf16 v[212:215], v[100:103], a[8:11], 0
    ds_read_b64_tr_b16 a[216:217], v17 offset:4096
    v_mfma_f32_16x16x32_bf16 v[220:223], v[100:103], a[12:15], 0
    ds_read_b64_tr_b16 a[218:219], v17 offset:6144
    s_waitcnt vmcnt(9)
    v_mfma_f32_16x16x32_bf16 v[192:195], v[104:107], a[16:19], v[192:195]
    s_add_u32 s38, s57, 12288
    buffer_load_dwordx4 v[144:147], v31, s[28:31], s38 offen offset:0 sc1
    ds_read_b64_tr_b16 a[220:221], v18 offset:4096
    v_mfma_f32_16x16x32_bf16 v[200:203], v[104:107], a[20:23], v[200:203]
    ds_read_b64_tr_b16 a[222:223], v18 offset:6144
    v_mfma_f32_16x16x32_bf16 v[208:211], v[104:107], a[24:27], v[208:211]
    v_mfma_f32_16x16x32_bf16 v[216:219], v[104:107], a[28:31], v[216:219]
    s_waitcnt vmcnt(9)
    v_mfma_f32_16x16x32_bf16 v[196:199], v[108:111], a[16:19], v[196:199]
    buffer_load_dwordx4 v[148:151], v31, s[28:31], s38 offen offset:1024 sc1
    v_mfma_f32_16x16x32_bf16 v[204:207], v[108:111], a[20:23], v[204:207]
    v_mfma_f32_16x16x32_bf16 v[212:215], v[108:111], a[24:27], v[212:215]
    v_mfma_f32_16x16x32_bf16 v[220:223], v[108:111], a[28:31], v[220:223]
    s_waitcnt vmcnt(9)
    v_mfma_f32_16x16x32_bf16 v[192:195], v[112:115], a[32:35], v[192:195]
    buffer_load_dwordx4 v[152:155], v31, s[28:31], s38 offen offset:2048 sc1
    v_mfma_f32_16x16x32_bf16 v[200:203], v[112:115], a[36:39], v[200:203]
    v_mfma_f32_16x16x32_bf16 v[208:211], v[112:115], a[40:43], v[208:211]
    v_mfma_f32_16x16x32_bf16 v[216:219], v[112:115], a[44:47], v[216:219]
    s_waitcnt vmcnt(9)
    v_mfma_f32_16x16x32_bf16 v[196:199], v[116:119], a[32:35], v[196:199]
    buffer_load_dwordx4 v[156:159], v31, s[28:31], s38 offen offset:3072 sc1
    v_mfma_f32_16x16x32_bf16 v[204:207], v[116:119], a[36:39], v[204:207]
    v_mfma_f32_16x16x32_bf16 v[212:215], v[116:119], a[40:43], v[212:215]
    v_mfma_f32_16x16x32_bf16 v[220:223], v[116:119], a[44:47], v[220:223]
    s_waitcnt vmcnt(9)
    v_mfma_f32_16x16x32_bf16 v[192:195], v[120:123], a[48:51], v[192:195]
    s_add_u32 s38, s57, 16384
    buffer_load_dwordx4 v[160:163], v31, s[28:31], s38 offen offset:0 sc1
    v_mfma_f32_16x16x32_bf16 v[200:203], v[120:123], a[52:55], v[200:203]
    v_mfma_f32_16x16x32_bf16 v[208:211], v[120:123], a[56:59], v[208:211]
    v_mfma_f32_16x16x32_bf16 v[216:219], v[120:123], a[60:63], v[216:219]
    s_waitcnt vmcnt(9)
    v_mfma_f32_16x16x32_bf16 v[196:199], v[124:127], a[48:51], v[196:199]
    buffer_load_dwordx4 v[164:167], v31, s[28:31], s38 offen offset:1024 sc1
    v_mfma_f32_16x16x32_bf16 v[204:207], v[124:127], a[52:55], v[204:207]
    v_mfma_f32_16x16x32_bf16 v[212:215], v[124:127], a[56:59], v[212:215]
    v_mfma_f32_16x16x32_bf16 v[220:223], v[124:127], a[60:63], v[220:223]
    s_waitcnt vmcnt(9)
    v_mfma_f32_16x16x32_bf16 v[192:195], v[128:131], a[64:67], v[192:195]
    s_add_u32 s65, s65, 512
    s_mov_b32 s69, 0
    s_atomic_add s69, s[18:19], s65 glc
    buffer_load_dwordx4 v[168:171], v31, s[28:31], s38 offen offset:2048 sc1
    v_mfma_f32_16x16x32_bf16 v[200:203], v[128:131], a[68:71], v[200:203]
    v_mfma_f32_16x16x32_bf16 v[208:211], v[128:131], a[72:75], v[208:211]
    v_mfma_f32_16x16x32_bf16 v[216:219], v[128:131], a[76:79], v[216:219]
    s_waitcnt vmcnt(9)
    v_mfma_f32_16x16x32_bf16 v[196:199], v[132:135], a[64:67], v[196:199]
    buffer_load_dwordx4 v[172:175], v31, s[28:31], s38 offen offset:3072 sc1
    v_mfma_f32_16x16x32_bf16 v[204:207], v[132:135], a[68:71], v[204:207]
    v_mfma_f32_16x16x32_bf16 v[212:215], v[132:135], a[72:75], v[212:215]
    v_mfma_f32_16x16x32_bf16 v[220:223], v[132:135], a[76:79], v[220:223]
    s_waitcnt vmcnt(9)
    v_mfma_f32_16x16x32_bf16 v[192:195], v[136:139], a[80:83], v[192:195]
    s_add_u32 s38, s57, 20480
    buffer_load_dwordx4 v[96:99], v31, s[28:31], s38 offen offset:0 sc1
    v_mfma_f32_16x16x32_bf16 v[200:203], v[136:139], a[84:87], v[200:203]
    v_mfma_f32_16x16x32_bf16 v[208:211], v[136:139], a[88:91], v[208:211]
    v_mfma_f32_16x16x32_bf16 v[216:219], v[136:139], a[92:95], v[216:219]
    s_waitcnt vmcnt(9)
    v_mfma_f32_16x16x32_bf16 v[196:199], v[140:143], a[80:83], v[196:199]
    buffer_load_dwordx4 v[100:103], v31, s[28:31], s38 offen offset:1024 sc1
    v_mfma_f32_16x16x32_bf16 v[204:207], v[140:143], a[84:87], v[204:207]
    v_mfma_f32_16x16x32_bf16 v[212:215], v[140:143], a[88:91], v[212:215]
    v_mfma_f32_16x16x32_bf16 v[220:223], v[140:143], a[92:95], v[220:223]
    s_waitcnt vmcnt(9)
    v_mfma_f32_16x16x32_bf16 v[192:195], v[144:147], a[96:99], v[192:195]
    buffer_load_dwordx4 v[104:107], v31, s[28:31], s38 offen offset:2048 sc1
    v_mfma_f32_16x16x32_bf16 v[200:203], v[144:147], a[100:103], v[200:203]
    v_mfma_f32_16x16x32_bf16 v[208:211], v[144:147], a[104:107], v[208:211]
    v_mfma_f32_16x16x32_bf16 v[216:219], v[144:147], a[108:111], v[216:219]
    s_waitcnt vmcnt(9)
    v_mfma_f32_16x16x32_bf16 v[196:199], v[148:151], a[96:99], v[196:199]
    buffer_load_dwordx4 v[108:111], v31, s[28:31], s38 offen offset:3072 sc1
    v_mfma_f32_16x16x32_bf16 v[204:207], v[148:151], a[100:103], v[204:207]
    v_mfma_f32_16x16x32_bf16 v[212:215], v[148:151], a[104:107], v[212:215]
    v_mfma_f32_16x16x32_bf16 v[220:223], v[148:151], a[108:111], v[220:223]
    s_waitcnt vmcnt(9)
    v_mfma_f32_16x16x32_bf16 v[192:195], v[152:155], a[112:115], v[192:195]
    s_add_u32 s38, s57, 24576
    buffer_load_dwordx4 v[112:115], v31, s[28:31], s38 offen offset:0 sc1
    v_mfma_f32_16x16x32_bf16 v[200:203], v[152:155], a[116:119], v[200:203]
    v_mfma_f32_16x16x32_bf16 v[208:211], v[152:155], a[120:123], v[208:211]
    v_mfma_f32_16x16x32_bf16 v[216:219], v[152:155], a[124:127], v[216:219]
    s_waitcnt vmcnt(9)
    v_mfma_f32_16x16x32_bf16 v[196:199], v[156:159], a[112:115], v[196:199]
    buffer_load_dwordx4 v[116:119], v31, s[28:31], s38 offen offset:1024 sc1
    v_mfma_f32_16x16x32_bf16 v[204:207], v[156:159], a[116:119], v[204:207]
    v_mfma_f32_16x16x32_bf16 v[212:215], v[156:159], a[120:123], v[212:215]
    v_mfma_f32_16x16x32_bf16 v[220:223], v[156:159], a[124:127], v[220:223]
    s_waitcnt vmcnt(9)
    v_mfma_f32_16x16x32_bf16 v[192:195], v[160:163], a[128:131], v[192:195]
    buffer_load_dwordx4 v[120:123], v31, s[28:31], s38 offen offset:2048 sc1
    v_mfma_f32_16x16x32_bf16 v[200:203], v[160:163], a[132:135], v[200:203]
    v_mfma_f32_16x16x32_bf16 v[208:211], v[160:163], a[136:139], v[208:211]
    v_mfma_f32_16x16x32_bf16 v[216:219], v[160:163], a[140:143], v[216:219]
    s_waitcnt vmcnt(9)
    v_mfma_f32_16x16x32_bf16 v[196:199], v[164:167], a[128:131], v[196:199]
    buffer_load_dwordx4 v[124:127], v31, s[28:31], s38 offen offset:3072 sc1
    v_mfma_f32_16x16x32_bf16 v[204:207], v[164:167], a[132:135], v[204:207]
    v_mfma_f32_16x16x32_bf16 v[212:215], v[164:167], a[136:139], v[212:215]
    v_mfma_f32_16x16x32_bf16 v[220:223], v[164:167], a[140:143], v[220:223]
    s_waitcnt vmcnt(9)
    v_mfma_f32_16x16x32_bf16 v[192:195], v[168:171], a[144:147], v[192:195]
    s_waitcnt lgkmcnt(0)
    s_cmp_eq_u32 s69, s70
    s_cbranch_scc1 L_poll2b_ok
    s_mov_b32 s40, 0x20000
L_poll2b:
    s_sleep 3
    s_mov_b32 s69, 0
    s_atomic_add s69, s[18:19], s65 glc
    s_waitcnt lgkmcnt(0)
    s_cmp_eq_u32 s69, s70
    s_cbranch_scc1 L_poll2b_ok
    s_sub_u32 s40, s40, 1
    s_cbranch_scc0 L_poll2b
L_poll2b_ok:
    s_add_u32 s38, s57, 114688
    buffer_load_dwordx4 v[128:131], v31, s[28:31], s38 offen offset:0 sc1
    v_mfma_f32_16x16x32_bf16 v[200:203], v[168:171], a[148:151], v[200:203]
    v_mfma_f32_16x16x32_bf16 v[208:211], v[168:171], a[152:155], v[208:211]
    v_mfma_f32_16x16x32_bf16 v[216:219], v[168:171], a[156:159], v[216:219]
    s_waitcnt vmcnt(9)
    v_mfma_f32_16x16x32_bf16 v[196:199], v[172:175], a[144:147], v[196:199]
    buffer_load_dwordx4 v[132:135], v31, s[28:31], s38 offen offset:1024 sc1
    v_mfma_f32_16x16x32_bf16 v[204:207], v[172:175], a[148:151], v[204:207]
    v_mfma_f32_16x16x32_bf16 v[212:215], v[172:175], a[152:155], v[212:215]
    v_mfma_f32_16x16x32_bf16 v[220:223], v[172:175], a[156:159], v[220:223]
    s_waitcnt vmcnt(9)
    v_mfma_f32_16x16x32_bf16 v[192:195], v[96:99], a[160:163], v[192:195]
    buffer_load_dwordx4 v[136:139], v31, s[28:31], s38 offen offset:2048 sc1
    v_mfma_f32_16x16x32_bf16 v[200:203], v[96:99], a[164:167], v[200:203]
    v_mfma_f32_16x16x32_bf16 v[208:211], v[96:99], a[168:171], v[208:211]
    v_mfma_f32_16x16x32_bf16 v[216:219], v[96:99], a[172:175], v[216:219]
    s_waitcnt vmcnt(9)
    v_mfma_f32_16x16x32_bf16 v[196:199], v[100:103], a[160:163], v[196:199]
    buffer_load_dwordx4 v[140:143], v31, s[28:31], s38 offen offset:3072 sc1
    v_mfma_f32_16x16x32_bf16 v[204:207], v[100:103], a[164:167], v[204:207]
    v_mfma_f32_16x16x32_bf16 v[212:215], v[100:103], a[168:171], v[212:215]
    v_mfma_f32_16x16x32_bf16 v[220:223], v[100:103], a[172:175], v[220:223]
    s_waitcnt vmcnt(9)
    v_mfma_f32_16x16x32_bf16 v[192:195], v[104:107], a[176:179], v[192:195]
    s_add_u32 s38, s57, 118784
    buffer_load_dwordx4 v[144:147], v31, s[28:31], s38 offen offset:0 sc1
    v_mfma_f32_16x16x32_bf16 v[200:203], v[104:107], a[180:183], v[200:203]
    v_mfma_f32_16x16x32_bf16 v[208:211], v[104:107], a[184:187], v[208:211]
    v_mfma_f32_16x16x32_bf16 v[216:219], v[104:107], a[188:191], v[216:219]
    s_waitcnt vmcnt(9)
    v_mfma_f32_16x16x32_bf16 v[196:199], v[108:111], a[176:179], v[196:199]
    buffer_load_dwordx4 v[148:151], v31, s[28:31], s38 offen offset:1024 sc1
    v_mfma_f32_16x16x32_bf16 v[204:207], v[108:111], a[180:183], v[204:207]
    v_mfma_f32_16x16x32_bf16 v[212:215], v[108:111], a[184:187], v[212:215]
    v_mfma_f32_16x16x32_bf16 v[220:223], v[108:111], a[188:191], v[220:223]
    s_waitcnt vmcnt(9)
    v_mfma_f32_16x16x32_bf16 v[192:195], v[112:115], a[192:195], v[192:195]
    buffer_load_dwordx4 v[152:155], v31, s[28:31], s38 offen offset:2048 sc1
    v_mfma_f32_16x16x32_bf16 v[200:203], v[112:115], a[196:199], v[200:203]
    v_mfma_f32_16x16x32_bf16 v[208:211], v[112:115], a[200:203], v[208:211]
    v_mfma_f32_16x16x32_bf16 v[216:219], v[112:115], a[204:207], v[216:219]
    s_waitcnt vmcnt(9)
    v_mfma_f32_16x16x32_bf16 v[196:199], v[116:119], a[192:195], v[196:199]
    buffer_load_dwordx4 v[156:159], v31, s[28:31], s38 offen offset:3072 sc1
    v_mfma_f32_16x16x32_bf16 v[204:207], v[116:119], a[196:199], v[204:207]
    v_mfma_f32_16x16x32_bf16 v[212:215], v[116:119], a[200:203], v[212:215]
    v_mfma_f32_16x16x32_bf16 v[220:223], v[116:119], a[204:207], v[220:223]
    s_waitcnt vmcnt(9)
    v_mfma_f32_16x16x32_bf16 v[192:195], v[120:123], a[208:211], v[192:195]
    s_add_u32 s38, s57, 122880
    buffer_load_dwordx4 v[160:163], v31, s[28:31], s38 offen offset:0 sc1
    v_mfma_f32_16x16x32_bf16 v[200:203], v[120:123], a[212:215], v[200:203]
    v_mfma_f32_16x16x32_bf16 v[208:211], v[120:123], a[216:219], v[208:211]
    v_mfma_f32_16x16x32_bf16 v[216:219], v[120:123], a[220:223], v[216:219]
    s_waitcnt vmcnt(9)
    v_mfma_f32_16x16x32_bf16 v[196:199], v[124:127], a[208:211], v[196:199]
    buffer_load_dwordx4 v[164:167], v31, s[28:31], s38 offen offset:1024 sc1
    v_mfma_f32_16x16x32_bf16 v[204:207], v[124:127], a[212:215], v[204:207]
    v_mfma_f32_16x16x32_bf16 v[212:215], v[124:127], a[216:219], v[212:215]
    v_mfma_f32_16x16x32_bf16 v[220:223], v[124:127], a[220:223], v[220:223]
    s_waitcnt vmcnt(9)
    v_mfma_f32_16x16x32_bf16 v[224:227], v[128:131], a[0:3], 0
    buffer_load_dwordx4 v[168:171], v31, s[28:31], s38 offen offset:2048 sc1
    v_mfma_f32_16x16x32_bf16 v[232:235], v[128:131], a[4:7], 0
    v_mfma_f32_16x16x32_bf16 v[240:243], v[128:131], a[8:11], 0
    v_mfma_f32_16x16x32_bf16 v[248:251], v[128:131], a[12:15], 0
    s_waitcnt vmcnt(9)
    v_mfma_f32_16x16x32_bf16 v[228:231], v[132:135], a[0:3], 0
    buffer_load_dwordx4 v[172:175], v31, s[28:31], s38 offen offset:3072 sc1
    v_mfma_f32_16x16x32_bf16 v[236:239], v[132:135], a[4:7], 0
    v_mfma_f32_16x16x32_bf16 v[244:247], v[132:135], a[8:11], 0
    v_mfma_f32_16x16x32_bf16 v[252:255], v[132:135], a[12:15], 0
    s_waitcnt vmcnt(9)
    v_mfma_f32_16x16x32_bf16 v[224:227], v[136:139], a[16:19], v[224:227]
    s_add_u32 s38, s57, 126976
    buffer_load_dwordx4 v[96:99], v31, s[28:31], s38 offen offset:0 sc1
    v_mfma_f32_16x16x32_bf16 v[232:235], v[136:139], a[20:23], v[232:235]
    s_mov_b32 m0, s79
    s_nop 0
    ds_write_addtid_b32 v200 offset:0
    ds_write_addtid_b32 v201 offset:256
    v_mfma_f32_16x16x32_bf16 v[240:243], v[136:139], a[24:27], v[240:243]
    ds_write_addtid_b32 v202 offset:512
    ds_write_addtid_b32 v203 offset:768
    v_mfma_f32_16x16x32_bf16 v[248:251], v[136:139], a[28:31], v[248:251]
    ds_write_addtid_b32 v204 offset:1024
    s_waitcnt vmcnt(9)
    v_mfma_f32_16x16x32_bf16 v[228:231], v[140:143], a[16:19], v[228:231]
    buffer_load_dwordx4 v[100:103], v31, s[28:31], s38 offen offset:1024 sc1
    v_mfma_f32_16x16x32_bf16 v[236:239], v[140:143], a[20:23], v[236:239]
    ds_write_addtid_b32 v205 offset:1280
    ds_write_addtid_b32 v206 offset:1536
    v_mfma_f32_16x16x32_bf16 v[244:247], v[140:143], a[24:27], v[244:247]
    ds_write_addtid_b32 v207 offset:1792
    ds_write_addtid_b32 v208 offset:2048
    v_mfma_f32_16x16x32_bf16 v[252:255], v[140:143], a[28:31], v[252:255]
    ds_write_addtid_b32 v209 offset:2304
    s_waitcnt vmcnt(9)
    v_mfma_f32_16x16x32_bf16 v[224:227], v[144:147], a[32:35], v[224:227]
    buffer_load_dwordx4 v[104:107], v31, s[28:31], s38 offen offset:2048 sc1
    v_mfma_f32_16x16x32_bf16 v[232:235], v[144:147], a[36:39], v[232:235]
    ds_write_addtid_b32 v210 offset:2560
    ds_write_addtid_b32 v211 offset:2816
    v_mfma_f32_16x16x32_bf16 v[240:243], v[144:147], a[40:43], v[240:243]
    ds_write_addtid_b32 v212 offset:3072
    ds_write_addtid_b32 v213 offset:3328
    v_mfma_f32_16x16x32_bf16 v[248:251], v[144:147], a[44:47], v[248:251]
    ds_write_addtid_b32 v214 offset:3584
    s_waitcnt vmcnt(9)
    v_mfma_f32_16x16x32_bf16 v[228:231], v[148:151], a[32:35], v[228:231]
    buffer_load_dwordx4 v[108:111], v31, s[28:31], s38 offen offset:3072 sc1
    v_mfma_f32_16x16x32_bf16 v[236:239], v[148:151], a[36:39], v[236:239]
    ds_write_addtid_b32 v215 offset:3840
    ds_write_addtid_b32 v216 offset:4096
    v_mfma_f32_16x16x32_bf16 v[244:247], v[148:151], a[40:43], v[244:247]
    ds_write_addtid_b32 v217 offset:4352
    ds_write_addtid_b32 v218 offset:4608
    v_mfma_f32_16x16x32_bf16 v[252:255], v[148:151], a[44:47], v[252:255]
    ds_write_addtid_b32 v219 offset:4864
    s_waitcnt vmcnt(9)
    v_mfma_f32_16x16x32_bf16 v[224:227], v[152:155], a[48:51], v[224:227]
    s_add_u32 s38, s57, 131072
    buffer_load_dwordx4 v[112:115], v31, s[28:31], s38 offen offset:0 sc1
    v_mfma_f32_16x16x32_bf16 v[232:235], v[152:155], a[52:55], v[232:235]
    ds_write_addtid_b32 v220 offset:5120
    ds_write_addtid_b32 v221 offset:5376
    v_mfma_f32_16x16x32_bf16 v[240:243], v[152:155], a[56:59], v[240:243]
    ds_write_addtid_b32 v222 offset:5632
    ds_write_addtid_b32 v223 offset:5888
    v_mfma_f32_16x16x32_bf16 v[248:251], v[152:155], a[60:63], v[248:251]
    s_waitcnt vmcnt(9)
    v_mfma_f32_16x16x32_bf16 v[228:231], v[156:159], a[48:51], v[228:231]
    buffer_load_dwordx4 v[116:119], v31, s[28:31], s38 offen offset:1024 sc1
    v_mfma_f32_16x16x32_bf16 v[236:239], v[156:159], a[52:55], v[236:239]
    v_mfma_f32_16x16x32_bf16 v[244:247], v[156:159], a[56:59], v[244:247]
    v_mfma_f32_16x16x32_bf16 v[252:255], v[156:159], a[60:63], v[252:255]
    s_waitcnt lgkmcnt(0)
    s_barrier
    s_waitcnt vmcnt(9)
    v_mfma_f32_16x16x32_bf16 v[224:227], v[160:163], a[64:67], v[224:227]
    buffer_load_dwordx4 v[120:123], v31, s[28:31], s38 offen offset:2048 sc1
    v_mfma_f32_16x16x32_bf16 v[232:235], v[160:163], a[68:71], v[232:235]
    ds_read2st64_b32 v[48:49], v186 offset0:0 offset1:1
    ds_read2st64_b32 v[50:51], v186 offset0:2 offset1:3
    v_mfma_f32_16x16x32_bf16 v[240:243], v[160:163], a[72:75], v[240:243]
    ds_read2st64_b32 v[52:53], v186 offset0:4 offset1:5
    ds_read2st64_b32 v[54:55], v186 offset0:6 offset1:7
    v_mfma_f32_16x16x32_bf16 v[248:251], v[160:163], a[76:79], v[248:251]
    ds_read2st64_b32 v[56:57], v187 offset0:8 offset1:9
    s_waitcnt vmcnt(9)
    v_mfma_f32_16x16x32_bf16 v[228:231], v[164:167], a[64:67], v[228:231]
    buffer_load_dwordx4 v[124:127], v31, s[28:31], s38 offen offset:3072 sc1
    v_mfma_f32_16x16x32_bf16 v[236:239], v[164:167], a[68:71], v[236:239]
    ds_read2st64_b32 v[58:59], v187 offset0:10 offset1:11
    ds_read2st64_b32 v[60:61], v187 offset0:12 offset1:13
    v_mfma_f32_16x16x32_bf16 v[244:247], v[164:167], a[72:75], v[244:247]
    ds_read2st64_b32 v[62:63], v187 offset0:14 offset1:15
    ds_read2st64_b32 v[64:65], v188 offset0:16 offset1:17
    v_mfma_f32_16x16x32_bf16 v[252:255], v[164:167], a[76:79], v[252:255]
    ds_read2st64_b32 v[66:67], v188 offset0:18 offset1:19
    s_waitcnt vmcnt(9)
    v_mfma_f32_16x16x32_bf16 v[224:227], v[168:171], a[80:83], v[224:227]
    s_add_u32 s38, s57, 135168
    buffer_load_dwordx4 v[128:131], v31, s[28:31], s38 offen offset:0 sc1
    v_mfma_f32_16x16x32_bf16 v[232:235], v[168:171], a[84:87], v[232:235]
    ds_read2st64_b32 v[68:69], v188 offset0:20 offset1:21
    ds_read2st64_b32 v[70:71], v188 offset0:22 offset1:23
    v_mfma_f32_16x16x32_bf16 v[240:243], v[168:171], a[88:91], v[240:243]
    v_mfma_f32_16x16x32_bf16 v[248:251], v[168:171], a[92:95], v[248:251]
    s_waitcnt vmcnt(9)
    v_mfma_f32_16x16x32_bf16 v[228:231], v[172:175], a[80:83], v[228:231]
    buffer_load_dwordx4 v[132:135], v31, s[28:31], s38 offen offset:1024 sc1
    v_mfma_f32_16x16x32_bf16 v[236:239], v[172:175], a[84:87], v[236:239]
    v_mfma_f32_16x16x32_bf16 v[244:247], v[172:175], a[88:91], v[244:247]
    v_mfma_f32_16x16x32_bf16 v[252:255], v[172:175], a[92:95], v[252:255]
    s_waitcnt vmcnt(9)
    v_mfma_f32_16x16x32_bf16 v[232:235], v[96:99], a[100:103], v[232:235]
    v_mfma_f32_16x16x32_bf16 v[240:243], v[96:99], a[104:107], v[240:243]
    buffer_load_dwordx4 v[136:139], v31, s[28:31], s38 offen offset:2048 sc1
    v_mfma_f32_16x16x32_bf16 v[248:251], v[96:99], a[108:111], v[248:251]
    s_waitcnt lgkmcnt(8)
    v_add_f32 v48, v48, v192
    s_waitcnt vmcnt(9)
    v_mfma_f32_16x16x32_bf16 v[236:239], v[100:103], a[100:103], v[236:239]
    v_add_f32 v49, v49, v193
    v_add_f32 v50, v50, v194
    v_mfma_f32_16x16x32_bf16 v[244:247], v[100:103], a[104:107], v[244:247]
    buffer_load_dwordx4 v[140:143], v31, s[28:31], s38 offen offset:3072 sc1
    v_add_f32 v51, v51, v195
    v_add_f32 v52, v52, v196
    v_mfma_f32_16x16x32_bf16 v[252:255], v[100:103], a[108:111], v[252:255]
    v_add_f32 v53, v53, v197
    s_waitcnt vmcnt(9)
    v_mfma_f32_16x16x32_bf16 v[232:235], v[104:107], a[116:119], v[232:235]
    v_add_f32 v54, v54, v198
    v_add_f32 v55, v55, v199
    v_mfma_f32_16x16x32_bf16 v[240:243], v[104:107], a[120:123], v[240:243]
    s_add_u32 s38, s57, 139264
    buffer_load_dwordx4 v[144:147], v31, s[28:31], s38 offen offset:0 sc1
    s_waitcnt lgkmcnt(0)
    v_add_f32 v56, v56, v64
    v_add_f32 v57, v57, v65
    v_mfma_f32_16x16x32_bf16 v[248:251], v[104:107], a[124:127], v[248:251]
    v_add_f32 v58, v58, v66
    s_waitcnt vmcnt(9)
    v_mfma_f32_16x16x32_bf16 v[236:239], v[108:111], a[116:119], v[236:239]
    v_add_f32 v59, v59, v67
    v_add_f32 v60, v60, v68
    v_mfma_f32_16x16x32_bf16 v[244:247], v[108:111], a[120:123], v[244:247]
    buffer_load_dwordx4 v[148:151], v31, s[28:31], s38 offen offset:1024 sc1
    v_add_f32 v61, v61, v69
    v_add_f32 v62, v62, v70
    v_mfma_f32_16x16x32_bf16 v[252:255], v[108:111], a[124:127], v[252:255]
    v_add_f32 v63, v63, v71
    s_waitcnt vmcnt(9)
    v_mfma_f32_16x16x32_bf16 v[232:235], v[112:115], a[132:135], v[232:235]
    v_add_f32 v48, v48, v56
    v_add_f32 v49, v49, v57
    v_mfma_f32_16x16x32_bf16 v[240:243], v[112:115], a[136:139], v[240:243]
    buffer_load_dwordx4 v[152:155], v31, s[28:31], s38 offen offset:2048 sc1
    v_add_f32 v50, v50, v58
    v_add_f32 v51, v51, v59
    v_mfma_f32_16x16x32_bf16 v[248:251], v[112:115], a[140:143], v[248:251]
    v_add_f32 v52, v52, v60
    s_waitcnt vmcnt(9)
    v_mfma_f32_16x16x32_bf16 v[236:239], v[116:119], a[132:135], v[236:239]
    v_add_f32 v53, v53, v61
    v_add_f32 v54, v54, v62
    v_mfma_f32_16x16x32_bf16 v[244:247], v[116:119], a[136:139], v[244:247]
    buffer_load_dwordx4 v[156:159], v31, s[28:31], s38 offen offset:3072 sc1
    v_add_f32 v55, v55, v63
    v_cvt_pk_bf16_f32 v48, 0, v48
    v_mfma_f32_16x16x32_bf16 v[252:255], v[116:119], a[140:143], v[252:255]
    v_cvt_pk_bf16_f32 v49, 0, v49
    s_waitcnt vmcnt(9)
    v_mfma_f32_16x16x32_bf16 v[232:235], v[120:123], a[148:151], v[232:235]
    v_cvt_pk_bf16_f32 v50, 0, v50
    v_cvt_pk_bf16_f32 v51, 0, v51
    v_mfma_f32_16x16x32_bf16 v[240:243], v[120:123], a[152:155], v[240:243]
    v_cvt_pk_bf16_f32 v52, 0, v52
    v_cvt_pk_bf16_f32 v53, 0, v53
    v_mfma_f32_16x16x32_bf16 v[248:251], v[120:123], a[156:159], v[248:251]
    v_cvt_pk_bf16_f32 v54, 0, v54
    s_waitcnt vmcnt(8)
    v_mfma_f32_16x16x32_bf16 v[236:239], v[124:127], a[148:151], v[236:239]
    v_cvt_pk_bf16_f32 v55, 0, v55
    v_add_f32 v48, v182, v48
    v_mfma_f32_16x16x32_bf16 v[244:247], v[124:127], a[152:155], v[244:247]
    v_add_f32 v49, v182, v49
    v_add_f32 v50, v182, v50
    v_mfma_f32_16x16x32_bf16 v[252:255], v[124:127], a[156:159], v[252:255]
    v_add_f32 v51, v182, v51
    s_waitcnt vmcnt(7)
    v_mfma_f32_16x16x32_bf16 v[232:235], v[128:131], a[164:167], v[232:235]
    v_add_f32 v52, v182, v52
    v_add_f32 v53, v182, v53
    v_mfma_f32_16x16x32_bf16 v[240:243], v[128:131], a[168:171], v[240:243]
    v_add_f32 v54, v182, v54
    v_add_f32 v55, v182, v55
    v_mfma_f32_16x16x32_bf16 v[248:251], v[128:131], a[172:175], v[248:251]
    v_cvt_pk_bf16_f32 v88, v48, v49
    s_waitcnt vmcnt(6)
    v_mfma_f32_16x16x32_bf16 v[236:239], v[132:135], a[164:167], v[236:239]
    v_cvt_pk_bf16_f32 v89, v50, v51
    v_cvt_pk_bf16_f32 v90, v52, v53
    v_mfma_f32_16x16x32_bf16 v[244:247], v[132:135], a[168:171], v[244:247]
    v_cvt_pk_bf16_f32 v91, v54, v55
    global_store_dwordx4 v24, v[88:91], s[14:15] offset:0 sc1
    v_mfma_f32_16x16x32_bf16 v[252:255], v[132:135], a[172:175], v[252:255]
    s_waitcnt vmcnt(6)
    v_mfma_f32_16x16x32_bf16 v[232:235], v[136:139], a[180:183], v[232:235]
    v_mfma_f32_16x16x32_bf16 v[240:243], v[136:139], a[184:187], v[240:243]
    v_mfma_f32_16x16x32_bf16 v[248:251], v[136:139], a[188:191], v[248:251]
    s_waitcnt vmcnt(5)
    v_mfma_f32_16x16x32_bf16 v[236:239], v[140:143], a[180:183], v[236:239]
    v_mfma_f32_16x16x32_bf16 v[244:247], v[140:143], a[184:187], v[244:247]
    v_mfma_f32_16x16x32_bf16 v[252:255], v[140:143], a[188:191], v[252:255]
    s_waitcnt vmcnt(4)
    v_mfma_f32_16x16x32_bf16 v[232:235], v[144:147], a[196:199], v[232:235]
    v_mfma_f32_16x16x32_bf16 v[240:243], v[144:147], a[200:203], v[240:243]
    v_mfma_f32_16x16x32_bf16 v[248:251], v[144:147], a[204:207], v[248:251]
    s_waitcnt vmcnt(3)
    v_mfma_f32_16x16x32_bf16 v[236:239], v[148:151], a[196:199], v[236:239]
    v_mfma_f32_16x16x32_bf16 v[244:247], v[148:151], a[200:203], v[244:247]
    v_mfma_f32_16x16x32_bf16 v[252:255], v[148:151], a[204:207], v[252:255]
    s_waitcnt vmcnt(2)
    v_mfma_f32_16x16x32_bf16 v[232:235], v[152:155], a[212:215], v[232:235]
    v_mfma_f32_16x16x32_bf16 v[240:243], v[152:155], a[216:219], v[240:243]
    v_mfma_f32_16x16x32_bf16 v[248:251], v[152:155], a[220:223], v[248:251]
    s_waitcnt vmcnt(1)
    v_mfma_f32_16x16x32_bf16 v[236:239], v[156:159], a[212:215], v[236:239]
    v_mfma_f32_16x16x32_bf16 v[244:247], v[156:159], a[216:219], v[244:247]
    v_mfma_f32_16x16x32_bf16 v[252:255], v[156:159], a[220:223], v[252:255]
    v_mfma_f32_16x16x32_bf16 v[224:227], v[96:99], a[96:99], v[224:227]
    v_mfma_f32_16x16x32_bf16 v[228:231], v[100:103], a[96:99], v[228:231]
    s_nop 5
    ds_write_b128 v27, v[232:235] offset:24576
    v_mfma_f32_16x16x32_bf16 v[224:227], v[104:107], a[112:115], v[224:227]
    v_mfma_f32_16x16x32_bf16 v[228:231], v[108:111], a[112:115], v[228:231]
    ds_write_b128 v27, v[236:239] offset:25600
    v_mfma_f32_16x16x32_bf16 v[224:227], v[112:115], a[128:131], v[224:227]
    v_mfma_f32_16x16x32_bf16 v[228:231], v[116:119], a[128:131], v[228:231]
    ds_write_b128 v27, v[240:243] offset:26624
    v_mfma_f32_16x16x32_bf16 v[224:227], v[120:123], a[144:147], v[224:227]
    v_mfma_f32_16x16x32_bf16 v[228:231], v[124:127], a[144:147], v[228:231]
    v_mfma_f32_16x16x32_bf16 v[224:227], v[128:131], a[160:163], v[224:227]
    ds_write_b128 v27, v[244:247] offset:27648
    v_mfma_f32_16x16x32_bf16 v[228:231], v[132:135], a[160:163], v[228:231]
    v_mfma_f32_16x16x32_bf16 v[224:227], v[136:139], a[176:179], v[224:227]
    ds_write_b128 v27, v[248:251] offset:28672
    v_mfma_f32_16x16x32_bf16 v[228:231], v[140:143], a[176:179], v[228:231]
    v_mfma_f32_16x16x32_bf16 v[224:227], v[144:147], a[192:195], v[224:227]
    ds_write_b128 v27, v[252:255] offset:29696
    v_mfma_f32_16x16x32_bf16 v[228:231], v[148:151], a[192:195], v[228:231]
    v_mfma_f32_16x16x32_bf16 v[224:227], v[152:155], a[208:211], v[224:227]
    v_mfma_f32_16x16x32_bf16 v[228:231], v[156:159], a[208:211], v[228:231]
    s_waitcnt lgkmcnt(0)
    s_barrier
    ds_read_b128 v[48:51], v28 offset:24576
    ds_read_b128 v[52:55], v28 offset:25600
    ds_read_b128 v[56:59], v29 offset:26624
    ds_read_b128 v[60:63], v29 offset:27648
    ds_read_b128 v[64:67], v30 offset:28672
    ds_read_b128 v[68:71], v30 offset:29696
    s_waitcnt lgkmcnt(4)
    v_pk_add_f32 v[48:49], v[48:49], v[224:225]
    v_pk_add_f32 v[50:51], v[50:51], v[226:227]
    v_pk_add_f32 v[52:53], v[52:53], v[228:229]
    v_pk_add_f32 v[54:55], v[54:55], v[230:231]
    s_waitcnt lgkmcnt(0)
    v_pk_add_f32 v[56:57], v[56:57], v[64:65]
    v_pk_add_f32 v[58:59], v[58:59], v[66:67]
    v_pk_add_f32 v[60:61], v[60:61], v[68:69]
    v_pk_add_f32 v[62:63], v[62:63], v[70:71]
    v_pk_add_f32 v[48:49], v[48:49], v[56:57]
    v_pk_add_f32 v[50:51], v[50:51], v[58:59]
    v_pk_add_f32 v[52:53], v[52:53], v[60:61]
    v_pk_add_f32 v[54:55], v[54:55], v[62:63]
    v_cvt_pk_bf16_f32 v48, 0, v48
    v_cvt_pk_bf16_f32 v49, 0, v49
    v_cvt_pk_bf16_f32 v50, 0, v50
    v_cvt_pk_bf16_f32 v51, 0, v51
    v_cvt_pk_bf16_f32 v52, 0, v52
    v_cvt_pk_bf16_f32 v53, 0, v53
    v_cvt_pk_bf16_f32 v54, 0, v54
    v_cvt_pk_bf16_f32 v55, 0, v55
    v_pk_add_f32 v[48:49], v[48:49], v[182:183]
    v_pk_add_f32 v[50:51], v[50:51], v[182:183]
    v_pk_add_f32 v[52:53], v[52:53], v[182:183]
    v_pk_add_f32 v[54:55], v[54:55], v[182:183]
    v_cvt_pk_bf16_f32 v92, v48, v49
    v_cvt_pk_bf16_f32 v93, v50, v51
    v_cvt_pk_bf16_f32 v94, v52, v53
    v_cvt_pk_bf16_f32 v95, v54, v55
    global_store_dwordx4 v24, v[92:95], s[14:15] offset:64 sc1
    s_or_b32 s40, s2, s32
    s_cmp_lg_u32 s40, 0
    s_cbranch_scc1 L_nobump
    v_mov_b32 v35, 4718592
    s_mov_b64 exec, 1
    global_store_dword v35, v32, s[18:19] sc1
    s_mov_b64 exec, -1
L_nobump:
L_done:
    s_endpgm
L_idle2:
    s_lshl_b32 s42, s2, 9
    s_lshl_b32 s43, s32, 7
    s_add_u32 s42, s42, s43
    s_add_u32 s64, s42, 4722688
    s_waitcnt vmcnt(0)
    s_atomic_swap s39, s[18:19], s66
    v_lshlrev_b32 v182, 16, v25
    v_lshlrev_b32 v183, 16, v25
    s_add_u32 m0, s36, 8192
    s_add_u32 s68, s68, 131072
    buffer_load_dwordx4 v7, s[24:27], s68 offen offset:0 lds
    buffer_load_dwordx4 v8, s[24:27], s68 offen offset:1024 lds
    buffer_load_dwordx4 v9, s[24:27], s68 offen offset:2048 lds
    buffer_load_dwordx4 v10, s[24:27], s68 offen offset:3072 lds
    s_add_u32 m0, s36, 12288
    s_add_u32 s68, s68, 131072
    buffer_load_dwordx4 v7, s[24:27], s68 offen offset:0 lds
    buffer_load_dwordx4 v8, s[24:27], s68 offen offset:1024 lds
    buffer_load_dwordx4 v9, s[24:27], s68 offen offset:2048 lds
    buffer_load_dwordx4 v10, s[24:27], s68 offen offset:3072 lds
    s_add_u32 m0, s36, 16384
    s_add_u32 s68, s68, 131072
    buffer_load_dwordx4 v7, s[24:27], s68 offen offset:0 lds
    buffer_load_dwordx4 v8, s[24:27], s68 offen offset:1024 lds
    buffer_load_dwordx4 v9, s[24:27], s68 offen offset:2048 lds
    buffer_load_dwordx4 v10, s[24:27], s68 offen offset:3072 lds
    s_add_u32 m0, s36, 20480
    s_add_u32 s68, s68, 131072
    buffer_load_dwordx4 v7, s[24:27], s68 offen offset:0 lds
    buffer_load_dwordx4 v8, s[24:27], s68 offen offset:1024 lds
    buffer_load_dwordx4 v9, s[24:27], s68 offen offset:2048 lds
    buffer_load_dwordx4 v10, s[24:27], s68 offen offset:3072 lds
    s_waitcnt vmcnt(12)
    ds_read_b64_tr_b16 a[0:1], v15 offset:8192
    ds_read_b64_tr_b16 a[2:3], v15 offset:10240
    ds_read_b64_tr_b16 a[4:5], v16 offset:8192
    s_and_b32 s40, s35, 3
    s_or_b32 s41, s35, 3
    s_lshl_b32 s41, s41, 7
    s_mul_i32 s42, s32, 1835008
    s_add_u32 s41, s41, s42
    s_add_u32 s42, s40, 4
    s_lshl_b32 s42, s42, 18
    s_add_u32 s41, s41, s42
    s_cmp_eq_u32 s40, 3
    s_cselect_b32 s41, 0x1000000, s41
    v_lshlrev_b32 v34, 12, v2
    buffer_load_dword v36, v34, s[24:27], s41 offen
    s_add_u32 m0, s36, 24576
    s_add_u32 s68, s68, 131072
    buffer_load_dwordx4 v7, s[24:27], s68 offen offset:0 lds
    ds_read_b64_tr_b16 a[6:7], v16 offset:10240
    ds_read_b64_tr_b16 a[8:9], v17 offset:8192
    ds_read_b64_tr_b16 a[10:11], v17 offset:10240
    buffer_load_dwordx4 v8, s[24:27], s68 offen offset:1024 lds
    ds_read_b64_tr_b16 a[12:13], v18 offset:8192
    ds_read_b64_tr_b16 a[14:15], v18 offset:10240
    buffer_load_dwordx4 v9, s[24:27], s68 offen offset:2048 lds
    s_waitcnt vmcnt(12)
    ds_read_b64_tr_b16 a[16:17], v15 offset:12288
    ds_read_b64_tr_b16 a[18:19], v15 offset:14336
    ds_read_b64_tr_b16 a[20:21], v16 offset:12288
    buffer_load_dwordx4 v10, s[24:27], s68 offen offset:3072 lds
    ds_read_b64_tr_b16 a[22:23], v16 offset:14336
    ds_read_b64_tr_b16 a[24:25], v17 offset:12288
    ds_read_b64_tr_b16 a[26:27], v17 offset:14336
    s_add_u32 m0, s36, 0
    s_add_u32 s68, s68, 131072
    buffer_load_dwordx4 v7, s[24:27], s68 offen offset:0 lds
    ds_read_b64_tr_b16 a[28:29], v18 offset:12288
    ds_read_b64_tr_b16 a[30:31], v18 offset:14336
    buffer_load_dwordx4 v8, s[24:27], s68 offen offset:1024 lds
    buffer_load_dwordx4 v9, s[24:27], s68 offen offset:2048 lds
    s_waitcnt vmcnt(12)
    ds_read_b64_tr_b16 a[32:33], v15 offset:16384
    ds_read_b64_tr_b16 a[34:35], v15 offset:18432
    ds_read_b64_tr_b16 a[36:37], v16 offset:16384
    buffer_load_dwordx4 v10, s[24:27], s68 offen offset:3072 lds
    ds_read_b64_tr_b16 a[38:39], v16 offset:18432
    ds_read_b64_tr_b16 a[40:41], v17 offset:16384
    ds_read_b64_tr_b16 a[42:43], v17 offset:18432
    s_add_u32 m0, s36, 4096
    s_add_u32 s68, s68, 131072
    buffer_load_dwordx4 v7, s[24:27], s68 offen offset:0 lds
    ds_read_b64_tr_b16 a[44:45], v18 offset:16384
    ds_read_b64_tr_b16 a[46:47], v18 offset:18432
    buffer_load_dwordx4 v8, s[24:27], s68 offen offset:1024 lds
    buffer_load_dwordx4 v9, s[24:27], s68 offen offset:2048 lds
    s_waitcnt vmcnt(12)
    ds_read_b64_tr_b16 a[48:49], v15 offset:20480
    ds_read_b64_tr_b16 a[50:51], v15 offset:22528
    ds_read_b64_tr_b16 a[52:53], v16 offset:20480
    buffer_load_dwordx4 v10, s[24:27], s68 offen offset:3072 lds
    ds_read_b64_tr_b16 a[54:55], v16 offset:22528
    ds_read_b64_tr_b16 a[56:57], v17 offset:20480
    ds_read_b64_tr_b16 a[58:59], v17 offset:22528
    s_waitcnt lgkmcnt(15)
    s_add_u32 m0, s36, 8192
    s_add_u32 s68, s68, 131072
    buffer_load_dwordx4 v7, s[24:27], s68 offen offset:0 lds
    ds_read_b64_tr_b16 a[60:61], v18 offset:20480
    ds_read_b64_tr_b16 a[62:63], v18 offset:22528
    buffer_load_dwordx4 v8, s[24:27], s68 offen offset:1024 lds
    buffer_load_dwordx4 v9, s[24:27], s68 offen offset:2048 lds
    buffer_load_dwordx4 v10, s[24:27], s68 offen offset:3072 lds
    s_waitcnt vmcnt(12)
    ds_read_b64_tr_b16 a[64:65], v15 offset:24576
    ds_read_b64_tr_b16 a[66:67], v15 offset:26624
    ds_read_b64_tr_b16 a[68:69], v16 offset:24576
    s_waitcnt lgkmcnt(15)
    s_add_u32 m0, s36, 12288
    s_add_u32 s68, s68, 131072
    buffer_load_dwordx4 v7, s[24:27], s68 offen offset:0 lds
    ds_read_b64_tr_b16 a[70:71], v16 offset:26624
    ds_read_b64_tr_b16 a[72:73], v17 offset:24576
    ds_read_b64_tr_b16 a[74:75], v17 offset:26624
    buffer_load_dwordx4 v8, s[24:27], s68 offen offset:1024 lds
    ds_read_b64_tr_b16 a[76:77], v18 offset:24576
    ds_read_b64_tr_b16 a[78:79], v18 offset:26624
    buffer_load_dwordx4 v9, s[24:27], s68 offen offset:2048 lds
    buffer_load_dwordx4 v10, s[24:27], s68 offen offset:3072 lds
    s_waitcnt vmcnt(12)
    ds_read_b64_tr_b16 a[80:81], v15 offset:0
    ds_read_b64_tr_b16 a[82:83], v15 offset:2048
    ds_read_b64_tr_b16 a[84:85], v16 offset:0
    s_waitcnt lgkmcnt(15)
    s_add_u32 m0, s36, 16384
    s_add_u32 s68, s68, 131072
    buffer_load_dwordx4 v7, s[24:27], s68 offen offset:0 lds
    ds_read_b64_tr_b16 a[86:87], v16 offset:2048
    ds_read_b64_tr_b16 a[88:89], v17 offset:0
    ds_read_b64_tr_b16 a[90:91], v17 offset:2048
    buffer_load_dwordx4 v8, s[24:27], s68 offen offset:1024 lds
    ds_read_b64_tr_b16 a[92:93], v18 offset:0
    ds_read_b64_tr_b16 a[94:95], v18 offset:2048
    buffer_load_dwordx4 v9, s[24:27], s68 offen offset:2048 lds
    buffer_load_dwordx4 v10, s[24:27], s68 offen offset:3072 lds
    s_waitcnt vmcnt(12)
    ds_read_b64_tr_b16 a[96:97], v15 offset:4096
    ds_read_b64_tr_b16 a[98:99], v15 offset:6144
    ds_read_b64_tr_b16 a[100:101], v16 offset:4096
    s_waitcnt lgkmcnt(15)
    s_add_u32 m0, s36, 20480
    s_add_u32 s68, s68, 131072
    buffer_load_dwordx4 v7, s[24:27], s68 offen offset:0 lds
    ds_read_b64_tr_b16 a[102:103], v16 offset:6144
    ds_read_b64_tr_b16 a[104:105], v17 offset:4096
    ds_read_b64_tr_b16 a[106:107], v17 offset:6144
    buffer_load_dwordx4 v8, s[24:27], s68 offen offset:1024 lds
    ds_read_b64_tr_b16 a[108:109], v18 offset:4096
    ds_read_b64_tr_b16 a[110:111], v18 offset:6144
    buffer_load_dwordx4 v9, s[24:27], s68 offen offset:2048 lds
    buffer_load_dwordx4 v10, s[24:27], s68 offen offset:3072 lds
    s_waitcnt vmcnt(12)
    ds_read_b64_tr_b16 a[112:113], v15 offset:8192
    ds_read_b64_tr_b16 a[114:115], v15 offset:10240
    ds_read_b64_tr_b16 a[116:117], v16 offset:8192
    s_waitcnt lgkmcnt(15)
    s_add_u32 m0, s36, 24576
    s_add_u32 s68, s68, 131072
    buffer_load_dwordx4 v7, s[24:27], s68 offen offset:0 lds
    ds_read_b64_tr_b16 a[118:119], v16 offset:10240
    ds_read_b64_tr_b16 a[120:121], v17 offset:8192
    ds_read_b64_tr_b16 a[122:123], v17 offset:10240
    buffer_load_dwordx4 v8, s[24:27], s68 offen offset:1024 lds
    ds_read_b64_tr_b16 a[124:125], v18 offset:8192
    ds_read_b64_tr_b16 a[126:127], v18 offset:10240
    buffer_load_dwordx4 v9, s[24:27], s68 offen offset:2048 lds
    buffer_load_dwordx4 v10, s[24:27], s68 offen offset:3072 lds
    s_waitcnt vmcnt(12)
    ds_read_b64_tr_b16 a[128:129], v15 offset:12288
    ds_read_b64_tr_b16 a[130:131], v15 offset:14336
    ds_read_b64_tr_b16 a[132:133], v16 offset:12288
    s_waitcnt lgkmcnt(15)
    s_add_u32 m0, s36, 0
    s_add_u32 s68, s68, 131072
    buffer_load_dwordx4 v7, s[24:27], s68 offen offset:0 lds
    ds_read_b64_tr_b16 a[134:135], v16 offset:14336
    ds_read_b64_tr_b16 a[136:137], v17 offset:12288
    ds_read_b64_tr_b16 a[138:139], v17 offset:14336
    buffer_load_dwordx4 v8, s[24:27], s68 offen offset:1024 lds
    ds_read_b64_tr_b16 a[140:141], v18 offset:12288
    ds_read_b64_tr_b16 a[142:143], v18 offset:14336
    buffer_load_dwordx4 v9, s[24:27], s68 offen offset:2048 lds
    buffer_load_dwordx4 v10, s[24:27], s68 offen offset:3072 lds
    s_waitcnt vmcnt(12)
    ds_read_b64_tr_b16 a[144:145], v15 offset:16384
    ds_read_b64_tr_b16 a[146:147], v15 offset:18432
    ds_read_b64_tr_b16 a[148:149], v16 offset:16384
    s_waitcnt lgkmcnt(15)
    s_add_u32 m0, s36, 4096
    s_add_u32 s68, s68, 131072
    buffer_load_dwordx4 v7, s[24:27], s68 offen offset:0 lds
    ds_read_b64_tr_b16 a[150:151], v16 offset:18432
    ds_read_b64_tr_b16 a[152:153], v17 offset:16384
    ds_read_b64_tr_b16 a[154:155], v17 offset:18432
    buffer_load_dwordx4 v8, s[24:27], s68 offen offset:1024 lds
    ds_read_b64_tr_b16 a[156:157], v18 offset:16384
    ds_read_b64_tr_b16 a[158:159], v18 offset:18432
    buffer_load_dwordx4 v9, s[24:27], s68 offen offset:2048 lds
    buffer_load_dwordx4 v10, s[24:27], s68 offen offset:3072 lds
    s_waitcnt vmcnt(12)
    ds_read_b64_tr_b16 a[160:161], v15 offset:20480
    ds_read_b64_tr_b16 a[162:163], v15 offset:22528
    ds_read_b64_tr_b16 a[164:165], v16 offset:20480
    ds_read_b64_tr_b16 a[166:167], v16 offset:22528
    ds_read_b64_tr_b16 a[168:169], v17 offset:20480
    ds_read_b64_tr_b16 a[170:171], v17 offset:22528
    ds_read_b64_tr_b16 a[172:173], v18 offset:20480
    ds_read_b64_tr_b16 a[174:175], v18 offset:22528
    s_waitcnt vmcnt(8)
    ds_read_b64_tr_b16 a[176:177], v15 offset:24576
    ds_read_b64_tr_b16 a[178:179], v15 offset:26624
    ds_read_b64_tr_b16 a[180:181], v16 offset:24576
    ds_read_b64_tr_b16 a[182:183], v16 offset:26624
    ds_read_b64_tr_b16 a[184:185], v17 offset:24576
    ds_read_b64_tr_b16 a[186:187], v17 offset:26624
    ds_read_b64_tr_b16 a[188:189], v18 offset:24576
    ds_read_b64_tr_b16 a[190:191], v18 offset:26624
    s_waitcnt vmcnt(4)
    ds_read_b64_tr_b16 a[192:193], v15 offset:0
    ds_read_b64_tr_b16 a[194:195], v15 offset:2048
    ds_read_b64_tr_b16 a[196:197], v16 offset:0
    ds_read_b64_tr_b16 a[198:199], v16 offset:2048
    ds_read_b64_tr_b16 a[200:201], v17 offset:0
    ds_read_b64_tr_b16 a[202:203], v17 offset:2048
    ds_read_b64_tr_b16 a[204:205], v18 offset:0
    ds_read_b64_tr_b16 a[206:207], v18 offset:2048
    s_waitcnt vmcnt(0)
    ds_read_b64_tr_b16 a[208:209], v15 offset:4096
    ds_read_b64_tr_b16 a[210:211], v15 offset:6144
    ds_read_b64_tr_b16 a[212:213], v16 offset:4096
    ds_read_b64_tr_b16 a[214:215], v16 offset:6144
    ds_read_b64_tr_b16 a[216:217], v17 offset:4096
    ds_read_b64_tr_b16 a[218:219], v17 offset:6144
    ds_read_b64_tr_b16 a[220:221], v18 offset:4096
    ds_read_b64_tr_b16 a[222:223], v18 offset:6144
    s_mov_b32 s69, 0
    s_atomic_add s69, s[18:19], s65 glc
    s_waitcnt lgkmcnt(0)
    s_cmp_eq_u32 s69, s70
    s_cbranch_scc1 L_poll2i_ok
    s_mov_b32 s40, 0x20000
L_poll2i:
    s_sleep 4
    s_mov_b32 s69, 0
    s_atomic_add s69, s[18:19], s65 glc
    s_waitcnt lgkmcnt(0)
    s_cmp_eq_u32 s69, s70
    s_cbranch_scc1 L_poll2i_ok
    s_sub_u32 s40, s40, 1
    s_cbranch_scc0 L_poll2i
L_poll2i_ok:
    s_waitcnt vmcnt(0) lgkmcnt(0)
    s_branch L_join2
L_end:
.section .rodata,"a"
.p2align 6
.amdhsa_kernel standalone__mixer_token_mlp__prompt_kernel
  .amdhsa_next_free_vgpr 512
  .amdhsa_next_free_sgpr 98
  .amdhsa_accum_offset 256
  .amdhsa_group_segment_fixed_size 0
  .amdhsa_kernarg_size 64
  .amdhsa_user_sgpr_count 2
  .amdhsa_user_sgpr_kernarg_segment_ptr 1
  .amdhsa_system_sgpr_workgroup_id_x 1
  .amdhsa_float_denorm_mode_32 3
.end_amdhsa_kernel
```
